```python
import torch

def _softmax(x, axis=-1):
    return torch.softmax(x, dim=axis)
def _gelu(x):
    return torch.nn.functional.gelu(x, approximate="tanh")
def _silu(x):
    return torch.nn.functional.silu(x)
def _sigmoid(x):
    return torch.sigmoid(x)
def _layernorm(x, axis=-1, eps=1e-5):
    m = x.mean(dim=axis, keepdim=True)
    v = x.var(dim=axis, keepdim=True, unbiased=False)
    return (x - m) / torch.sqrt(v + eps)
def _scatter_add(tgt, idx, src, axis=0):
    return tgt.clone().index_add_(axis, idx, src)
def _segment_sum(src, seg, n):
    out = torch.zeros((n,) + src.shape[1:], dtype=src.dtype)
    return out.index_add_(0, seg, src)
def _pad(x, pw):
    flat = tuple(v for pair in reversed(pw) for v in pair)
    return torch.nn.functional.pad(x, flat)

kernel_name = 'parallel_sum__ssm_conv_s4d__dense_activation_mish__prompt'

def setup_inputs():

    _w = (lambda a: (lambda t: t.to(torch.bfloat16) if t.is_floating_point() else t)(torch.as_tensor(a)))
    def _A_setup():
        Bsz, L, D, N = 1, 2048, 640, 128
        return {
            "u": _w((lambda *s: torch.randn(*s, dtype=torch.bfloat16) * 0.05)(Bsz, L, D)),
            "log_A_real": _w((lambda *s: torch.randn(*s, dtype=torch.bfloat16) * 3.2)(D, N) * 0.5),
            "A_imag": _w((lambda *s: torch.randn(*s, dtype=torch.bfloat16) * 0.05)(D, N) * 3.14),
            "C_real": _w((lambda *s: torch.randn(*s, dtype=torch.bfloat16) * 0.2)(D, N) / N ** 0.5),
            "C_imag": _w((lambda *s: torch.randn(*s, dtype=torch.bfloat16) * 0.2)(D, N) / N ** 0.5),
            "log_dt": _w((lambda *s: torch.randn(*s, dtype=torch.bfloat16) * 0.05)(D) * 0.5 - 4.0),
            "D_skip": _w((lambda *s: torch.randn(*s, dtype=torch.bfloat16) * 0.05)(D)),
        }
    _A_in = _A_setup()

    def _B_setup():
        B, S, D, F = 1, 2048, 640, 1728
        return {
            "x": _w((lambda *s: torch.randn(*s, dtype=torch.bfloat16) * 0.05)(B, S, D)),
            "w1": _w((lambda *s: torch.randn(*s, dtype=torch.bfloat16) * 0.8)(D, F) * (D ** -0.5)),
            "b1": _w((lambda *s: torch.randn(*s, dtype=torch.bfloat16) * 0.2)(F)),
            "w2": _w((lambda *s: torch.randn(*s, dtype=torch.bfloat16) * 0.2)(F, D) * (F ** -0.5)),
        }
    _B_in = _B_setup()

    return {
        "A_u": _A_in["u"],
        "A_log_A_real": _A_in["log_A_real"],
        "A_A_imag": _A_in["A_imag"],
        "A_C_real": _A_in["C_real"],
        "A_C_imag": _A_in["C_imag"],
        "A_log_dt": _A_in["log_dt"],
        "A_D_skip": _A_in["D_skip"],
        "B_x": _B_in["x"],
        "B_w1": _B_in["w1"],
        "B_b1": _B_in["b1"],
        "B_w2": _B_in["w2"],
    }

def reference(A_u, A_log_A_real, A_A_imag, A_C_real, A_C_imag, A_log_dt, A_D_skip, B_x, B_w1, B_b1, B_w2):
    def _A_ref(u, log_A_real, A_imag, C_real, C_imag, log_dt, D_skip):
        L = u.shape[1]
        dt = torch.exp(log_dt)
        A = -torch.exp(log_A_real) + 1j * A_imag
        C = (C_real + 1j * C_imag) * dt[:, None]
        pos = (lambda x, dt: x.to(dt))(torch.arange(L), log_dt.dtype)
        P = torch.exp((A * dt[:, None])[:, :, None] * pos[None, None, :])
        K = 2.0 * torch.einsum("dn,dnl->dl", C, P).real
        L2 = 2 * L
        u_t = (lambda x, *d: x.permute(*d))(u, 0, 2, 1)
        Kf = (lambda x, *a, **k: torch.fft.rfft(x.float(), *a, **k))(K, L2)
        Uf = (lambda x, *a, **k: torch.fft.rfft(x.float(), *a, **k))(u_t, L2)
        y = (lambda x, *a, **k: torch.fft.irfft(x, *a, **k).to(torch.bfloat16))(Uf * Kf[None, :, :], L2)[:, :, :L]
        y = (lambda x, *d: x.permute(*d))(y, 0, 2, 1)
        return y + u * D_skip[None, None, :]

    def _B_ref(x, w1, b1, w2):
        h = torch.einsum("bsd,df->bsf", x, w1) + b1
        sp = torch.log1p(torch.exp(-torch.abs(h))) + torch.where(h > 0, h, torch.zeros_like(h))
        act = h * torch.tanh(sp)
        return torch.einsum("bsf,fd->bsd", act, w2)

    x = A_u
    xn = _layernorm(x, axis=-1)
    return x + _A_ref(xn, A_log_A_real, A_A_imag, A_C_real, A_C_imag, A_log_dt, A_D_skip) + _B_ref(xn, B_w1, B_b1, B_w2)
```

```asm
; @launch kernel=prep_kernel grid=(903,1,1) block=(256,1,1) lds=36864
; @launch kernel=mid_kernel grid=(896,1,1) block=(256,1,1) lds=40960
.amdgcn_target "amdgcn-amd-amdhsa--gfx950"
.text
.globl prep_kernel
.p2align 8
.type prep_kernel,@function
prep_kernel:
    s_cmp_ge_u32 s2, 903
    s_cbranch_scc1 prep_end
    s_load_dwordx2 s[56:57], s[0:1], 104
    v_lshrrev_b32 v1, 6, v0
    v_and_b32 v2, 63, v0
    s_nop 0
    v_readfirstlane_b32 s3, v1
    s_cmp_ge_u32 s2, 768
    s_cbranch_scc1 prep_wt
    s_cmp_ge_u32 s2, 640
    s_cbranch_scc1 prep_ln
    s_load_dwordx4 s[40:43], s[0:1], 8
    s_load_dwordx4 s[44:47], s[0:1], 24
    s_load_dwordx2 s[48:49], s[0:1], 40
    s_mov_b32 s4, s2
    s_mul_i32 s5, s3, 512
    s_lshl_b32 s6, s4, 8
    s_lshl_b32 s7, s3, 6
    s_add_u32 s6, s6, s7
    v_and_b32 v3, 31, v2
    v_lshl_add_u32 v3, v3, 1, s6
    s_lshl_b32 s7, s4, 1
    v_mov_b32 v4, s7
    s_waitcnt lgkmcnt(0)
    s_mov_b32 s8, s40
    s_and_b32 s9, s41, 0xffff
    s_mov_b32 s10, 163840
    s_mov_b32 s11, 0x00020000
    s_mov_b32 s12, s42
    s_and_b32 s13, s43, 0xffff
    s_mov_b32 s14, 163840
    s_mov_b32 s15, 0x00020000
    s_mov_b32 s16, s44
    s_and_b32 s17, s45, 0xffff
    s_mov_b32 s18, 163840
    s_mov_b32 s19, 0x00020000
    s_mov_b32 s20, s46
    s_and_b32 s21, s47, 0xffff
    s_mov_b32 s22, 163840
    s_mov_b32 s23, 0x00020000
    s_mov_b32 s24, s48
    s_and_b32 s25, s49, 0xffff
    s_mov_b32 s26, 1280
    s_mov_b32 s27, 0x00020000
    s_mov_b32 s28, s56
    s_and_b32 s29, s57, 0xffff
    s_mov_b32 s30, 268435456
    s_mov_b32 s31, 0x00020000
    buffer_load_ushort v10, v3, s[8:11], 0 offen
    buffer_load_ushort v11, v3, s[12:15], 0 offen
    buffer_load_ushort v12, v3, s[16:19], 0 offen
    buffer_load_ushort v13, v3, s[20:23], 0 offen
    buffer_load_ushort v18, v4, s[24:27], 0 offen
    v_and_b32 v8, 15, v2
    v_lshrrev_b32 v9, 4, v2
    v_and_b32 v24, 7, v8
    v_lshrrev_b32 v25, 3, v8
    v_lshl_add_u32 v28, v25, 7, v24
    v_and_b32 v24, 3, v8
    v_lshlrev_b32 v24, 1, v24
    v_bfe_u32 v25, v8, 2, 1
    v_lshl_add_u32 v24, v25, 7, v24
    v_add_u32 v24, 256, v24
    v_and_b32 v25, 1, v8
    v_lshlrev_b32 v25, 2, v25
    v_bfe_u32 v26, v8, 1, 2
    v_lshl_add_u32 v25, v26, 7, v25
    v_add_u32 v25, 512, v25
    v_cmp_gt_u32 vcc, 8, v8
    s_nop 1
    v_cndmask_b32 v29, v25, v24, vcc
    v_lshlrev_b32 v30, 7, v8
    v_add_u32 v30, 0x400, v30
    v_lshlrev_b32 v31, 3, v8
    v_cvt_f32_u32 v28, v28
    v_cvt_f32_u32 v29, v29
    v_cvt_f32_u32 v30, v30
    v_cvt_f32_u32 v31, v31
    s_mul_i32 s6, s3, 2688
    s_add_u32 s6, s6, 2048
    v_and_b32 v24, 1, v9
    v_lshrrev_b32 v25, 1, v9
    v_lshl_add_u32 v33, v8, 5, s6
    v_lshl_add_u32 v33, v24, 4, v33
    v_lshl_add_u32 v33, v25, 9, v33
    v_lshlrev_b32 v24, 4, v8
    v_lshlrev_b32 v25, 3, v8
    v_cmp_gt_u32 vcc, 2, v9
    s_nop 1
    v_cndmask_b32 v24, v25, v24, vcc
    v_lshl_add_u32 v24, v9, 8, v24
    v_add_u32 v24, s6, v24
    v_add_u32 v34, 1024, v24
    v_mov_b32 v25, 128
    v_cndmask_b32_e64 v24, v25, 8, vcc
    v_add_u32 v36, v34, v24
    v_lshl_add_u32 v38, v8, 2, s6
    v_lshl_add_u32 v38, v9, 8, v38
    v_add_u32 v38, 2048, v38
    v_lshl_add_u32 v39, v9, 4, s5
    v_mov_b32 v40, 0
    v_mov_b32 v41, 0
    v_mov_b32 v42, 0
    v_mov_b32 v43, 0
    v_mov_b32 v44, 0
    v_mov_b32 v45, 0
    v_mov_b32 v46, 0
    v_mov_b32 v47, 0
    v_mov_b32 v48, 0
    v_mov_b32 v49, 0
    v_mov_b32 v50, 0
    v_mov_b32 v51, 0
    s_waitcnt vmcnt(0)
    v_lshlrev_b32 v10, 16, v10
    v_lshlrev_b32 v11, 16, v11
    v_lshlrev_b32 v12, 16, v12
    v_lshlrev_b32 v13, 16, v13
    v_lshlrev_b32 v18, 16, v18
    v_mul_f32 v18, 0x3fb8aa3b, v18
    v_mul_f32 v10, 0x3fb8aa3b, v10
    v_exp_f32 v18, v18
    v_exp_f32 v10, v10
    s_nop 0
    v_cvt_pk_bf16_f32 v18, v18, v18
    v_cvt_pk_bf16_f32 v10, v10, v10
    v_lshlrev_b32 v18, 16, v18
    v_lshlrev_b32 v10, 16, v10
    v_add_f32 v19, v18, v18
    v_and_b32 v5, 31, v2
    v_lshl_add_u32 v5, v5, 4, s5
    v_mul_f32 v20, v10, v18
    v_mul_f32 v20, 0xbfb8aa3b, v20
    v_mul_f32 v21, v11, v18
    v_mul_f32 v21, 0x3e22f983, v21
    v_mul_f32 v22, v12, v19
    v_mul_f32 v23, v13, v19
    ds_write_b128 v5, v[20:23]
    s_waitcnt lgkmcnt(0)
    ds_read_b128 v[96:99], v39 offset:0
    ds_read_b128 v[100:103], v39 offset:64
    ds_read_b128 v[104:107], v39 offset:128
    ds_read_b128 v[108:111], v39 offset:192
    ds_read_b128 v[112:115], v39 offset:256
    ds_read_b128 v[116:119], v39 offset:320
    ds_read_b128 v[120:123], v39 offset:384
    ds_read_b128 v[124:127], v39 offset:448
    s_waitcnt lgkmcnt(0)
    v_mul_f32 v52, v96, v28
    v_mul_f32 v56, v97, v28
    v_mul_f32 v53, v96, v29
    v_mul_f32 v57, v97, v29
    v_mul_f32 v54, v96, v30
    v_mul_f32 v58, v97, v30
    v_mul_f32 v55, v96, v31
    v_mul_f32 v59, v97, v31
    v_exp_f32 v52, v52
    v_fract_f32 v56, v56
    v_exp_f32 v53, v53
    v_fract_f32 v57, v57
    v_exp_f32 v54, v54
    v_fract_f32 v58, v58
    v_exp_f32 v55, v55
    v_fract_f32 v59, v59
    v_cos_f32 v60, v56
    v_sin_f32 v64, v56
    v_cos_f32 v61, v57
    v_sin_f32 v65, v57
    v_cos_f32 v62, v58
    v_sin_f32 v66, v58
    v_cos_f32 v63, v59
    v_sin_f32 v67, v59
    v_mul_f32 v60, v52, v60
    v_mul_f32 v64, v52, v64
    v_mul_f32 v61, v53, v61
    v_mul_f32 v65, v53, v65
    v_mul_f32 v62, v54, v62
    v_mul_f32 v66, v54, v66
    v_mul_f32 v63, v55, v63
    v_mul_f32 v67, v55, v67
    v_mul_f32 v55, v63, v98
    v_mul_f32_e64 v59, -v63, v99
    v_fma_f32 v55, -v67, v99, v55
    v_fma_f32 v59, -v67, v98, v59
    v_cvt_pk_bf16_f32 v72, v55, v59
    v_lshlrev_b32 v68, 16, v72
    v_and_b32 v69, 0xffff0000, v72
    v_sub_f32 v68, v55, v68
    v_sub_f32 v69, v59, v69
    v_cvt_pk_bf16_f32 v74, v68, v69
    v_mov_b32 v73, v72
    v_mov_b32 v75, v74
    v_cvt_pk_bf16_f32 v76, v60, v64
    v_lshlrev_b32 v52, 16, v76
    v_and_b32 v56, 0xffff0000, v76
    v_sub_f32 v52, v60, v52
    v_sub_f32 v56, v64, v56
    v_cvt_pk_bf16_f32 v77, v52, v56
    v_cvt_pk_bf16_f32 v78, v61, v65
    v_lshlrev_b32 v53, 16, v78
    v_and_b32 v57, 0xffff0000, v78
    v_sub_f32 v53, v61, v53
    v_sub_f32 v57, v65, v57
    v_cvt_pk_bf16_f32 v79, v53, v57
    v_cvt_pk_bf16_f32 v80, v62, v66
    v_lshlrev_b32 v54, 16, v80
    v_and_b32 v58, 0xffff0000, v80
    v_sub_f32 v54, v62, v54
    v_sub_f32 v58, v66, v58
    v_cvt_pk_bf16_f32 v81, v54, v58
    v_mul_f32 v52, v100, v28
    v_mul_f32 v56, v101, v28
    v_mfma_f32_16x16x16_bf16 v[40:43], v[76:77], v[72:73], v[40:43]
    v_mul_f32 v53, v100, v29
    v_mul_f32 v57, v101, v29
    v_mul_f32 v54, v100, v30
    v_mul_f32 v58, v101, v30
    v_mul_f32 v55, v100, v31
    v_mul_f32 v59, v101, v31
    v_exp_f32 v52, v52
    v_mfma_f32_16x16x16_bf16 v[44:47], v[78:79], v[72:73], v[44:47]
    v_fract_f32 v56, v56
    v_exp_f32 v53, v53
    v_fract_f32 v57, v57
    v_exp_f32 v54, v54
    v_fract_f32 v58, v58
    v_exp_f32 v55, v55
    v_fract_f32 v59, v59
    v_mfma_f32_16x16x16_bf16 v[48:51], v[80:81], v[72:73], v[48:51]
    v_cos_f32 v60, v56
    v_sin_f32 v64, v56
    v_cos_f32 v61, v57
    v_sin_f32 v65, v57
    v_cos_f32 v62, v58
    v_sin_f32 v66, v58
    v_cos_f32 v63, v59
    v_mfma_f32_16x16x16_bf16 v[40:43], v[76:77], v[74:75], v[40:43]
    v_sin_f32 v67, v59
    v_mul_f32 v60, v52, v60
    v_mul_f32 v64, v52, v64
    v_mul_f32 v61, v53, v61
    v_mul_f32 v65, v53, v65
    v_mul_f32 v62, v54, v62
    v_mul_f32 v66, v54, v66
    v_mfma_f32_16x16x16_bf16 v[44:47], v[78:79], v[74:75], v[44:47]
    v_mul_f32 v63, v55, v63
    v_mul_f32 v67, v55, v67
    v_mul_f32 v55, v63, v102
    v_mul_f32_e64 v59, -v63, v103
    v_fma_f32 v55, -v67, v103, v55
    v_fma_f32 v59, -v67, v102, v59
    v_cvt_pk_bf16_f32 v82, v55, v59
    v_mfma_f32_16x16x16_bf16 v[48:51], v[80:81], v[74:75], v[48:51]
    v_lshlrev_b32 v68, 16, v82
    v_and_b32 v69, 0xffff0000, v82
    v_sub_f32 v68, v55, v68
    v_sub_f32 v69, v59, v69
    v_cvt_pk_bf16_f32 v84, v68, v69
    v_mov_b32 v83, v82
    v_mov_b32 v85, v84
    v_cvt_pk_bf16_f32 v86, v60, v64
    v_lshlrev_b32 v52, 16, v86
    v_and_b32 v56, 0xffff0000, v86
    v_sub_f32 v52, v60, v52
    v_sub_f32 v56, v64, v56
    v_cvt_pk_bf16_f32 v87, v52, v56
    v_cvt_pk_bf16_f32 v88, v61, v65
    v_lshlrev_b32 v53, 16, v88
    v_and_b32 v57, 0xffff0000, v88
    v_sub_f32 v53, v61, v53
    v_sub_f32 v57, v65, v57
    v_cvt_pk_bf16_f32 v89, v53, v57
    v_cvt_pk_bf16_f32 v90, v62, v66
    v_lshlrev_b32 v54, 16, v90
    v_and_b32 v58, 0xffff0000, v90
    v_sub_f32 v54, v62, v54
    v_sub_f32 v58, v66, v58
    v_cvt_pk_bf16_f32 v91, v54, v58
    v_mul_f32 v52, v104, v28
    v_mul_f32 v56, v105, v28
    v_mfma_f32_16x16x16_bf16 v[40:43], v[86:87], v[82:83], v[40:43]
    v_mul_f32 v53, v104, v29
    v_mul_f32 v57, v105, v29
    v_mul_f32 v54, v104, v30
    v_mul_f32 v58, v105, v30
    v_mul_f32 v55, v104, v31
    v_mul_f32 v59, v105, v31
    v_exp_f32 v52, v52
    v_mfma_f32_16x16x16_bf16 v[44:47], v[88:89], v[82:83], v[44:47]
    v_fract_f32 v56, v56
    v_exp_f32 v53, v53
    v_fract_f32 v57, v57
    v_exp_f32 v54, v54
    v_fract_f32 v58, v58
    v_exp_f32 v55, v55
    v_fract_f32 v59, v59
    v_mfma_f32_16x16x16_bf16 v[48:51], v[90:91], v[82:83], v[48:51]
    v_cos_f32 v60, v56
    v_sin_f32 v64, v56
    v_cos_f32 v61, v57
    v_sin_f32 v65, v57
    v_cos_f32 v62, v58
    v_sin_f32 v66, v58
    v_cos_f32 v63, v59
    v_mfma_f32_16x16x16_bf16 v[40:43], v[86:87], v[84:85], v[40:43]
    v_sin_f32 v67, v59
    v_mul_f32 v60, v52, v60
    v_mul_f32 v64, v52, v64
    v_mul_f32 v61, v53, v61
    v_mul_f32 v65, v53, v65
    v_mul_f32 v62, v54, v62
    v_mul_f32 v66, v54, v66
    v_mfma_f32_16x16x16_bf16 v[44:47], v[88:89], v[84:85], v[44:47]
    v_mul_f32 v63, v55, v63
    v_mul_f32 v67, v55, v67
    v_mul_f32 v55, v63, v106
    v_mul_f32_e64 v59, -v63, v107
    v_fma_f32 v55, -v67, v107, v55
    v_fma_f32 v59, -v67, v106, v59
    v_cvt_pk_bf16_f32 v72, v55, v59
    v_mfma_f32_16x16x16_bf16 v[48:51], v[90:91], v[84:85], v[48:51]
    v_lshlrev_b32 v68, 16, v72
    v_and_b32 v69, 0xffff0000, v72
    v_sub_f32 v68, v55, v68
    v_sub_f32 v69, v59, v69
    v_cvt_pk_bf16_f32 v74, v68, v69
    v_mov_b32 v73, v72
    v_mov_b32 v75, v74
    v_cvt_pk_bf16_f32 v76, v60, v64
    v_lshlrev_b32 v52, 16, v76
    v_and_b32 v56, 0xffff0000, v76
    v_sub_f32 v52, v60, v52
    v_sub_f32 v56, v64, v56
    v_cvt_pk_bf16_f32 v77, v52, v56
    v_cvt_pk_bf16_f32 v78, v61, v65
    v_lshlrev_b32 v53, 16, v78
    v_and_b32 v57, 0xffff0000, v78
    v_sub_f32 v53, v61, v53
    v_sub_f32 v57, v65, v57
    v_cvt_pk_bf16_f32 v79, v53, v57
    v_cvt_pk_bf16_f32 v80, v62, v66
    v_lshlrev_b32 v54, 16, v80
    v_and_b32 v58, 0xffff0000, v80
    v_sub_f32 v54, v62, v54
    v_sub_f32 v58, v66, v58
    v_cvt_pk_bf16_f32 v81, v54, v58
    v_mul_f32 v52, v108, v28
    v_mul_f32 v56, v109, v28
    v_mfma_f32_16x16x16_bf16 v[40:43], v[76:77], v[72:73], v[40:43]
    v_mul_f32 v53, v108, v29
    v_mul_f32 v57, v109, v29
    v_mul_f32 v54, v108, v30
    v_mul_f32 v58, v109, v30
    v_mul_f32 v55, v108, v31
    v_mul_f32 v59, v109, v31
    v_exp_f32 v52, v52
    v_mfma_f32_16x16x16_bf16 v[44:47], v[78:79], v[72:73], v[44:47]
    v_fract_f32 v56, v56
    v_exp_f32 v53, v53
    v_fract_f32 v57, v57
    v_exp_f32 v54, v54
    v_fract_f32 v58, v58
    v_exp_f32 v55, v55
    v_fract_f32 v59, v59
    v_mfma_f32_16x16x16_bf16 v[48:51], v[80:81], v[72:73], v[48:51]
    v_cos_f32 v60, v56
    v_sin_f32 v64, v56
    v_cos_f32 v61, v57
    v_sin_f32 v65, v57
    v_cos_f32 v62, v58
    v_sin_f32 v66, v58
    v_cos_f32 v63, v59
    v_mfma_f32_16x16x16_bf16 v[40:43], v[76:77], v[74:75], v[40:43]
    v_sin_f32 v67, v59
    v_mul_f32 v60, v52, v60
    v_mul_f32 v64, v52, v64
    v_mul_f32 v61, v53, v61
    v_mul_f32 v65, v53, v65
    v_mul_f32 v62, v54, v62
    v_mul_f32 v66, v54, v66
    v_mfma_f32_16x16x16_bf16 v[44:47], v[78:79], v[74:75], v[44:47]
    v_mul_f32 v63, v55, v63
    v_mul_f32 v67, v55, v67
    v_mul_f32 v55, v63, v110
    v_mul_f32_e64 v59, -v63, v111
    v_fma_f32 v55, -v67, v111, v55
    v_fma_f32 v59, -v67, v110, v59
    v_cvt_pk_bf16_f32 v82, v55, v59
    v_mfma_f32_16x16x16_bf16 v[48:51], v[80:81], v[74:75], v[48:51]
    v_lshlrev_b32 v68, 16, v82
    v_and_b32 v69, 0xffff0000, v82
    v_sub_f32 v68, v55, v68
    v_sub_f32 v69, v59, v69
    v_cvt_pk_bf16_f32 v84, v68, v69
    v_mov_b32 v83, v82
    v_mov_b32 v85, v84
    v_cvt_pk_bf16_f32 v86, v60, v64
    v_lshlrev_b32 v52, 16, v86
    v_and_b32 v56, 0xffff0000, v86
    v_sub_f32 v52, v60, v52
    v_sub_f32 v56, v64, v56
    v_cvt_pk_bf16_f32 v87, v52, v56
    v_cvt_pk_bf16_f32 v88, v61, v65
    v_lshlrev_b32 v53, 16, v88
    v_and_b32 v57, 0xffff0000, v88
    v_sub_f32 v53, v61, v53
    v_sub_f32 v57, v65, v57
    v_cvt_pk_bf16_f32 v89, v53, v57
    v_cvt_pk_bf16_f32 v90, v62, v66
    v_lshlrev_b32 v54, 16, v90
    v_and_b32 v58, 0xffff0000, v90
    v_sub_f32 v54, v62, v54
    v_sub_f32 v58, v66, v58
    v_cvt_pk_bf16_f32 v91, v54, v58
    v_mul_f32 v52, v112, v28
    v_mul_f32 v56, v113, v28
    v_mfma_f32_16x16x16_bf16 v[40:43], v[86:87], v[82:83], v[40:43]
    v_mul_f32 v53, v112, v29
    v_mul_f32 v57, v113, v29
    v_mul_f32 v54, v112, v30
    v_mul_f32 v58, v113, v30
    v_mul_f32 v55, v112, v31
    v_mul_f32 v59, v113, v31
    v_exp_f32 v52, v52
    v_mfma_f32_16x16x16_bf16 v[44:47], v[88:89], v[82:83], v[44:47]
    v_fract_f32 v56, v56
    v_exp_f32 v53, v53
    v_fract_f32 v57, v57
    v_exp_f32 v54, v54
    v_fract_f32 v58, v58
    v_exp_f32 v55, v55
    v_fract_f32 v59, v59
    v_mfma_f32_16x16x16_bf16 v[48:51], v[90:91], v[82:83], v[48:51]
    v_cos_f32 v60, v56
    v_sin_f32 v64, v56
    v_cos_f32 v61, v57
    v_sin_f32 v65, v57
    v_cos_f32 v62, v58
    v_sin_f32 v66, v58
    v_cos_f32 v63, v59
    v_mfma_f32_16x16x16_bf16 v[40:43], v[86:87], v[84:85], v[40:43]
    v_sin_f32 v67, v59
    v_mul_f32 v60, v52, v60
    v_mul_f32 v64, v52, v64
    v_mul_f32 v61, v53, v61
    v_mul_f32 v65, v53, v65
    v_mul_f32 v62, v54, v62
    v_mul_f32 v66, v54, v66
    v_mfma_f32_16x16x16_bf16 v[44:47], v[88:89], v[84:85], v[44:47]
    v_mul_f32 v63, v55, v63
    v_mul_f32 v67, v55, v67
    v_mul_f32 v55, v63, v114
    v_mul_f32_e64 v59, -v63, v115
    v_fma_f32 v55, -v67, v115, v55
    v_fma_f32 v59, -v67, v114, v59
    v_cvt_pk_bf16_f32 v72, v55, v59
    v_mfma_f32_16x16x16_bf16 v[48:51], v[90:91], v[84:85], v[48:51]
    v_lshlrev_b32 v68, 16, v72
    v_and_b32 v69, 0xffff0000, v72
    v_sub_f32 v68, v55, v68
    v_sub_f32 v69, v59, v69
    v_cvt_pk_bf16_f32 v74, v68, v69
    v_mov_b32 v73, v72
    v_mov_b32 v75, v74
    v_cvt_pk_bf16_f32 v76, v60, v64
    v_lshlrev_b32 v52, 16, v76
    v_and_b32 v56, 0xffff0000, v76
    v_sub_f32 v52, v60, v52
    v_sub_f32 v56, v64, v56
    v_cvt_pk_bf16_f32 v77, v52, v56
    v_cvt_pk_bf16_f32 v78, v61, v65
    v_lshlrev_b32 v53, 16, v78
    v_and_b32 v57, 0xffff0000, v78
    v_sub_f32 v53, v61, v53
    v_sub_f32 v57, v65, v57
    v_cvt_pk_bf16_f32 v79, v53, v57
    v_cvt_pk_bf16_f32 v80, v62, v66
    v_lshlrev_b32 v54, 16, v80
    v_and_b32 v58, 0xffff0000, v80
    v_sub_f32 v54, v62, v54
    v_sub_f32 v58, v66, v58
    v_cvt_pk_bf16_f32 v81, v54, v58
    v_mul_f32 v52, v116, v28
    v_mul_f32 v56, v117, v28
    v_mfma_f32_16x16x16_bf16 v[40:43], v[76:77], v[72:73], v[40:43]
    v_mul_f32 v53, v116, v29
    v_mul_f32 v57, v117, v29
    v_mul_f32 v54, v116, v30
    v_mul_f32 v58, v117, v30
    v_mul_f32 v55, v116, v31
    v_mul_f32 v59, v117, v31
    v_exp_f32 v52, v52
    v_mfma_f32_16x16x16_bf16 v[44:47], v[78:79], v[72:73], v[44:47]
    v_fract_f32 v56, v56
    v_exp_f32 v53, v53
    v_fract_f32 v57, v57
    v_exp_f32 v54, v54
    v_fract_f32 v58, v58
    v_exp_f32 v55, v55
    v_fract_f32 v59, v59
    v_mfma_f32_16x16x16_bf16 v[48:51], v[80:81], v[72:73], v[48:51]
    v_cos_f32 v60, v56
    v_sin_f32 v64, v56
    v_cos_f32 v61, v57
    v_sin_f32 v65, v57
    v_cos_f32 v62, v58
    v_sin_f32 v66, v58
    v_cos_f32 v63, v59
    v_mfma_f32_16x16x16_bf16 v[40:43], v[76:77], v[74:75], v[40:43]
    v_sin_f32 v67, v59
    v_mul_f32 v60, v52, v60
    v_mul_f32 v64, v52, v64
    v_mul_f32 v61, v53, v61
    v_mul_f32 v65, v53, v65
    v_mul_f32 v62, v54, v62
    v_mul_f32 v66, v54, v66
    v_mfma_f32_16x16x16_bf16 v[44:47], v[78:79], v[74:75], v[44:47]
    v_mul_f32 v63, v55, v63
    v_mul_f32 v67, v55, v67
    v_mul_f32 v55, v63, v118
    v_mul_f32_e64 v59, -v63, v119
    v_fma_f32 v55, -v67, v119, v55
    v_fma_f32 v59, -v67, v118, v59
    v_cvt_pk_bf16_f32 v82, v55, v59
    v_mfma_f32_16x16x16_bf16 v[48:51], v[80:81], v[74:75], v[48:51]
    v_lshlrev_b32 v68, 16, v82
    v_and_b32 v69, 0xffff0000, v82
    v_sub_f32 v68, v55, v68
    v_sub_f32 v69, v59, v69
    v_cvt_pk_bf16_f32 v84, v68, v69
    v_mov_b32 v83, v82
    v_mov_b32 v85, v84
    v_cvt_pk_bf16_f32 v86, v60, v64
    v_lshlrev_b32 v52, 16, v86
    v_and_b32 v56, 0xffff0000, v86
    v_sub_f32 v52, v60, v52
    v_sub_f32 v56, v64, v56
    v_cvt_pk_bf16_f32 v87, v52, v56
    v_cvt_pk_bf16_f32 v88, v61, v65
    v_lshlrev_b32 v53, 16, v88
    v_and_b32 v57, 0xffff0000, v88
    v_sub_f32 v53, v61, v53
    v_sub_f32 v57, v65, v57
    v_cvt_pk_bf16_f32 v89, v53, v57
    v_cvt_pk_bf16_f32 v90, v62, v66
    v_lshlrev_b32 v54, 16, v90
    v_and_b32 v58, 0xffff0000, v90
    v_sub_f32 v54, v62, v54
    v_sub_f32 v58, v66, v58
    v_cvt_pk_bf16_f32 v91, v54, v58
    v_mul_f32 v52, v120, v28
    v_mul_f32 v56, v121, v28
    v_mfma_f32_16x16x16_bf16 v[40:43], v[86:87], v[82:83], v[40:43]
    v_mul_f32 v53, v120, v29
    v_mul_f32 v57, v121, v29
    v_mul_f32 v54, v120, v30
    v_mul_f32 v58, v121, v30
    v_mul_f32 v55, v120, v31
    v_mul_f32 v59, v121, v31
    v_exp_f32 v52, v52
    v_mfma_f32_16x16x16_bf16 v[44:47], v[88:89], v[82:83], v[44:47]
    v_fract_f32 v56, v56
    v_exp_f32 v53, v53
    v_fract_f32 v57, v57
    v_exp_f32 v54, v54
    v_fract_f32 v58, v58
    v_exp_f32 v55, v55
    v_fract_f32 v59, v59
    v_mfma_f32_16x16x16_bf16 v[48:51], v[90:91], v[82:83], v[48:51]
    v_cos_f32 v60, v56
    v_sin_f32 v64, v56
    v_cos_f32 v61, v57
    v_sin_f32 v65, v57
    v_cos_f32 v62, v58
    v_sin_f32 v66, v58
    v_cos_f32 v63, v59
    v_mfma_f32_16x16x16_bf16 v[40:43], v[86:87], v[84:85], v[40:43]
    v_sin_f32 v67, v59
    v_mul_f32 v60, v52, v60
    v_mul_f32 v64, v52, v64
    v_mul_f32 v61, v53, v61
    v_mul_f32 v65, v53, v65
    v_mul_f32 v62, v54, v62
    v_mul_f32 v66, v54, v66
    v_mfma_f32_16x16x16_bf16 v[44:47], v[88:89], v[84:85], v[44:47]
    v_mul_f32 v63, v55, v63
    v_mul_f32 v67, v55, v67
    v_mul_f32 v55, v63, v122
    v_mul_f32_e64 v59, -v63, v123
    v_fma_f32 v55, -v67, v123, v55
    v_fma_f32 v59, -v67, v122, v59
    v_cvt_pk_bf16_f32 v72, v55, v59
    v_mfma_f32_16x16x16_bf16 v[48:51], v[90:91], v[84:85], v[48:51]
    v_lshlrev_b32 v68, 16, v72
    v_and_b32 v69, 0xffff0000, v72
    v_sub_f32 v68, v55, v68
    v_sub_f32 v69, v59, v69
    v_cvt_pk_bf16_f32 v74, v68, v69
    v_mov_b32 v73, v72
    v_mov_b32 v75, v74
    v_cvt_pk_bf16_f32 v76, v60, v64
    v_lshlrev_b32 v52, 16, v76
    v_and_b32 v56, 0xffff0000, v76
    v_sub_f32 v52, v60, v52
    v_sub_f32 v56, v64, v56
    v_cvt_pk_bf16_f32 v77, v52, v56
    v_cvt_pk_bf16_f32 v78, v61, v65
    v_lshlrev_b32 v53, 16, v78
    v_and_b32 v57, 0xffff0000, v78
    v_sub_f32 v53, v61, v53
    v_sub_f32 v57, v65, v57
    v_cvt_pk_bf16_f32 v79, v53, v57
    v_cvt_pk_bf16_f32 v80, v62, v66
    v_lshlrev_b32 v54, 16, v80
    v_and_b32 v58, 0xffff0000, v80
    v_sub_f32 v54, v62, v54
    v_sub_f32 v58, v66, v58
    v_cvt_pk_bf16_f32 v81, v54, v58
    v_mul_f32 v52, v124, v28
    v_mul_f32 v56, v125, v28
    v_mfma_f32_16x16x16_bf16 v[40:43], v[76:77], v[72:73], v[40:43]
    v_mul_f32 v53, v124, v29
    v_mul_f32 v57, v125, v29
    v_mul_f32 v54, v124, v30
    v_mul_f32 v58, v125, v30
    v_mul_f32 v55, v124, v31
    v_mul_f32 v59, v125, v31
    v_exp_f32 v52, v52
    v_mfma_f32_16x16x16_bf16 v[44:47], v[78:79], v[72:73], v[44:47]
    v_fract_f32 v56, v56
    v_exp_f32 v53, v53
    v_fract_f32 v57, v57
    v_exp_f32 v54, v54
    v_fract_f32 v58, v58
    v_exp_f32 v55, v55
    v_fract_f32 v59, v59
    v_mfma_f32_16x16x16_bf16 v[48:51], v[80:81], v[72:73], v[48:51]
    v_cos_f32 v60, v56
    v_sin_f32 v64, v56
    v_cos_f32 v61, v57
    v_sin_f32 v65, v57
    v_cos_f32 v62, v58
    v_sin_f32 v66, v58
    v_cos_f32 v63, v59
    v_mfma_f32_16x16x16_bf16 v[40:43], v[76:77], v[74:75], v[40:43]
    v_sin_f32 v67, v59
    v_mul_f32 v60, v52, v60
    v_mul_f32 v64, v52, v64
    v_mul_f32 v61, v53, v61
    v_mul_f32 v65, v53, v65
    v_mul_f32 v62, v54, v62
    v_mul_f32 v66, v54, v66
    v_mfma_f32_16x16x16_bf16 v[44:47], v[78:79], v[74:75], v[44:47]
    v_mul_f32 v63, v55, v63
    v_mul_f32 v67, v55, v67
    v_mul_f32 v55, v63, v126
    v_mul_f32_e64 v59, -v63, v127
    v_fma_f32 v55, -v67, v127, v55
    v_fma_f32 v59, -v67, v126, v59
    v_cvt_pk_bf16_f32 v82, v55, v59
    v_mfma_f32_16x16x16_bf16 v[48:51], v[80:81], v[74:75], v[48:51]
    v_lshlrev_b32 v68, 16, v82
    v_and_b32 v69, 0xffff0000, v82
    v_sub_f32 v68, v55, v68
    v_sub_f32 v69, v59, v69
    v_cvt_pk_bf16_f32 v84, v68, v69
    v_mov_b32 v83, v82
    v_mov_b32 v85, v84
    v_cvt_pk_bf16_f32 v86, v60, v64
    v_lshlrev_b32 v52, 16, v86
    v_and_b32 v56, 0xffff0000, v86
    v_sub_f32 v52, v60, v52
    v_sub_f32 v56, v64, v56
    v_cvt_pk_bf16_f32 v87, v52, v56
    v_cvt_pk_bf16_f32 v88, v61, v65
    v_lshlrev_b32 v53, 16, v88
    v_and_b32 v57, 0xffff0000, v88
    v_sub_f32 v53, v61, v53
    v_sub_f32 v57, v65, v57
    v_cvt_pk_bf16_f32 v89, v53, v57
    v_cvt_pk_bf16_f32 v90, v62, v66
    v_lshlrev_b32 v54, 16, v90
    v_and_b32 v58, 0xffff0000, v90
    v_sub_f32 v54, v62, v54
    v_sub_f32 v58, v66, v58
    v_cvt_pk_bf16_f32 v91, v54, v58
    s_nop 1
    v_mfma_f32_16x16x16_bf16 v[40:43], v[86:87], v[82:83], v[40:43]
    v_mfma_f32_16x16x16_bf16 v[44:47], v[88:89], v[82:83], v[44:47]
    v_mfma_f32_16x16x16_bf16 v[48:51], v[90:91], v[82:83], v[48:51]
    v_mfma_f32_16x16x16_bf16 v[40:43], v[86:87], v[84:85], v[40:43]
    v_mfma_f32_16x16x16_bf16 v[44:47], v[88:89], v[84:85], v[44:47]
    v_mfma_f32_16x16x16_bf16 v[48:51], v[90:91], v[84:85], v[48:51]
    s_nop 15
    ds_write_b32 v33, v40 offset:0
    ds_write_b32 v33, v41 offset:4
    ds_write_b32 v33, v42 offset:8
    ds_write_b32 v33, v43 offset:12
    ds_write_b32 v34, v44
    ds_write_b32 v34, v45 offset:4
    ds_write_b32 v36, v46
    ds_write_b32 v36, v47 offset:4
    s_mov_b32 exec_hi, 0xffff
    ds_write_b32 v38, v48
    s_mov_b32 exec_hi, 0
    ds_write_b32 v38, v49 offset:64
    ds_write_b32 v38, v50 offset:128
    ds_write_b32 v38, v51 offset:192
    s_mov_b32 exec_hi, -1
    s_mul_i32 s4, s4, 4224
    s_add_u32 s4, s4, 10485760
    v_lshlrev_b32 v39, 4, v0
    v_lshlrev_b32 v64, 3, v0
    v_sub_u32 v64, 2047, v64
    v_lshlrev_b32 v65, 2, v0
    v_lshlrev_b32 v66, 1, v0
    v_subrev_u32 v52, 0, v64
    v_cvt_f32_u32 v72, v52
    v_subrev_u32 v53, 1, v64
    v_cvt_f32_u32 v73, v53
    v_subrev_u32 v54, 2, v64
    v_cvt_f32_u32 v74, v54
    v_subrev_u32 v55, 3, v64
    v_cvt_f32_u32 v75, v55
    v_subrev_u32 v56, 4, v64
    v_cvt_f32_u32 v76, v56
    v_subrev_u32 v57, 5, v64
    v_cvt_f32_u32 v77, v57
    v_subrev_u32 v58, 6, v64
    v_cvt_f32_u32 v78, v58
    v_subrev_u32 v59, 7, v64
    v_cvt_f32_u32 v79, v59
    v_cvt_pk_bf16_f32 v80, v72, v73
    v_and_b32 v72, 0xffff, v80
    v_lshrrev_b32 v73, 16, v80
    v_cvt_pk_bf16_f32 v81, v74, v75
    v_and_b32 v74, 0xffff, v81
    v_lshrrev_b32 v75, 16, v81
    v_cvt_pk_bf16_f32 v82, v76, v77
    v_and_b32 v76, 0xffff, v82
    v_lshrrev_b32 v77, 16, v82
    v_cvt_pk_bf16_f32 v83, v78, v79
    v_and_b32 v78, 0xffff, v83
    v_lshrrev_b32 v79, 16, v83
    v_subrev_u32 v72, 17024, v72
    v_cmp_gt_u32 vcc, 256, v52
    s_nop 1
    v_cndmask_b32 v52, v72, v52, vcc
    v_lshlrev_b32 v52, 1, v52
    v_subrev_u32 v73, 17024, v73
    v_cmp_gt_u32 vcc, 256, v53
    s_nop 1
    v_cndmask_b32 v53, v73, v53, vcc
    v_lshlrev_b32 v53, 1, v53
    v_subrev_u32 v74, 17024, v74
    v_cmp_gt_u32 vcc, 256, v54
    s_nop 1
    v_cndmask_b32 v54, v74, v54, vcc
    v_lshlrev_b32 v54, 1, v54
    v_subrev_u32 v75, 17024, v75
    v_cmp_gt_u32 vcc, 256, v55
    s_nop 1
    v_cndmask_b32 v55, v75, v55, vcc
    v_lshlrev_b32 v55, 1, v55
    v_subrev_u32 v76, 17024, v76
    v_cmp_gt_u32 vcc, 256, v56
    s_nop 1
    v_cndmask_b32 v56, v76, v56, vcc
    v_lshlrev_b32 v56, 1, v56
    v_subrev_u32 v77, 17024, v77
    v_cmp_gt_u32 vcc, 256, v57
    s_nop 1
    v_cndmask_b32 v57, v77, v57, vcc
    v_lshlrev_b32 v57, 1, v57
    v_subrev_u32 v78, 17024, v78
    v_cmp_gt_u32 vcc, 256, v58
    s_nop 1
    v_cndmask_b32 v58, v78, v58, vcc
    v_lshlrev_b32 v58, 1, v58
    v_subrev_u32 v79, 17024, v79
    v_cmp_gt_u32 vcc, 256, v59
    s_nop 1
    v_cndmask_b32 v59, v79, v59, vcc
    v_lshlrev_b32 v59, 1, v59
    s_waitcnt lgkmcnt(0)
    s_barrier
    ds_read_b32 v72, v65 offset:2048
    ds_read_b32 v73, v65 offset:4736
    ds_read_b32 v74, v65 offset:7424
    ds_read_b32 v75, v65 offset:10112
    ds_read_b32 v76, v65 offset:3072
    ds_read_b32 v77, v65 offset:5760
    ds_read_b32 v78, v65 offset:8448
    ds_read_b32 v79, v65 offset:11136
    ds_read_b32 v80, v65 offset:4096
    ds_read_b32 v81, v65 offset:6784
    ds_read_b32 v82, v65 offset:9472
    ds_read_b32 v83, v65 offset:12160
    s_waitcnt lgkmcnt(8)
    v_add_f32 v72, v72, v73
    v_add_f32 v74, v74, v75
    v_add_f32 v72, v72, v74
    v_cvt_pk_bf16_f32 v72, v72, v72
    ds_write_b16 v66, v72 offset:12800
    s_waitcnt lgkmcnt(4)
    v_add_f32 v76, v76, v77
    v_add_f32 v78, v78, v79
    v_add_f32 v76, v76, v78
    v_cvt_pk_bf16_f32 v76, v76, v76
    ds_write_b16 v66, v76 offset:13312
    s_waitcnt lgkmcnt(0)
    v_add_f32 v80, v80, v81
    v_add_f32 v82, v82, v83
    v_add_f32 v80, v80, v82
    v_cvt_pk_bf16_f32 v80, v80, v80
    ds_write_b16 v66, v80 offset:13824
    s_waitcnt lgkmcnt(0)
    s_barrier
    ds_read_u16 v96, v52 offset:12800
    ds_read_u16 v97, v53 offset:12800
    ds_read_u16 v98, v54 offset:12800
    ds_read_u16 v99, v55 offset:12800
    ds_read_u16 v100, v56 offset:12800
    ds_read_u16 v101, v57 offset:12800
    ds_read_u16 v102, v58 offset:12800
    ds_read_u16 v103, v59 offset:12800
    s_waitcnt lgkmcnt(0)
    v_lshl_or_b32 v112, v97, 16, v96
    v_lshl_or_b32 v113, v99, 16, v98
    v_lshl_or_b32 v114, v101, 16, v100
    v_lshl_or_b32 v115, v103, 16, v102
    buffer_store_dwordx4 v[112:115], v39, s[28:31], s4 offen sc1
    v_mov_b32 v116, 0
    v_mov_b32 v117, 0
    v_mov_b32 v118, 0
    v_mov_b32 v119, 0
    v_cmp_gt_u32 vcc, 8, v0
    s_and_saveexec_b64 s[32:33], vcc
    s_cbranch_execz prep_end
    s_add_u32 s4, s4, 4096
    buffer_store_dwordx4 v[116:119], v39, s[28:31], s4 offen sc1
    s_cmp_ge_u32 s2, 256
    s_cbranch_scc1 prep_end
    v_lshlrev_b32 v40, 3, v0
    s_lshl_b32 s4, s2, 7
    s_add_u32 s4, s4, 24379392
    buffer_store_dwordx2 v[116:117], v40, s[28:31], s4 offen sc1
    v_lshlrev_b32 v40, 4, v0
    s_lshl_b32 s4, s2, 9
    s_add_u32 s4, s4, 24641536
    buffer_store_dwordx4 v[116:119], v40, s[28:31], s4 offen offset:0 sc1
    buffer_store_dwordx4 v[116:119], v40, s[28:31], s4 offen offset:128 sc1
    buffer_store_dwordx4 v[116:119], v40, s[28:31], s4 offen offset:256 sc1
    v_lshlrev_b32 v39, 12, v0
    s_cmp_lg_u32 s2, 0
    s_cbranch_scc1 prep_end
    s_mov_b32 s4, 24117248
    buffer_store_dword v116, v39, s[28:31], s4 offen sc1
    s_add_u32 s4, s4, 32768
    buffer_store_dword v116, v39, s[28:31], s4 offen sc1
    s_add_u32 s4, s4, 32768
    buffer_store_dword v116, v39, s[28:31], s4 offen sc1
    s_endpgm
prep_ln:
    s_setprio 3
    s_load_dwordx2 s[40:41], s[0:1], 0
    s_sub_u32 s2, s2, 640
    v_and_b32 v3, 15, v0
    v_lshrrev_b32 v4, 4, v0
    s_lshl_b32 s5, s2, 4
    v_add_u32 v5, s5, v4
    v_mul_u32_u24 v6, 1280, v5
    v_lshl_add_u32 v6, v3, 4, v6
    s_waitcnt lgkmcnt(0)
    s_mov_b32 s8, s40
    s_and_b32 s9, s41, 0xffff
    s_mov_b32 s10, 2621440
    s_mov_b32 s11, 0x00020000
    s_mov_b32 s28, s56
    s_and_b32 s29, s57, 0xffff
    s_mov_b32 s30, 268435456
    s_mov_b32 s31, 0x00020000
    s_sleep 16
    buffer_load_dwordx4 v[16:19], v6, s[8:11], 0 offen offset:0
    buffer_load_dwordx4 v[20:23], v6, s[8:11], 0 offen offset:256
    buffer_load_dwordx4 v[24:27], v6, s[8:11], 0 offen offset:512
    buffer_load_dwordx4 v[28:31], v6, s[8:11], 0 offen offset:768
    buffer_load_dwordx4 v[32:35], v6, s[8:11], 0 offen offset:1024
    s_lshr_b32 s6, s2, 1
    s_mul_i32 s6, s6, 40960
    s_add_u32 s6, s6, 0
    v_lshrrev_b32 v7, 1, v3
    v_lshlrev_b32 v7, 10, v7
    v_and_b32 v8, 1, v3
    v_lshl_add_u32 v7, v8, 9, v7
    v_and_b32 v8, 31, v5
    v_lshl_add_u32 v7, v8, 4, v7
    v_mul_u32_u24 v9, 288, v3
    v_lshl_add_u32 v9, v4, 1, v9
    s_waitcnt vmcnt(0)
    v_lshlrev_b32 v40, 16, v16
    v_and_b32 v41, 0xffff0000, v16
    v_lshlrev_b32 v42, 16, v17
    v_and_b32 v43, 0xffff0000, v17
    v_lshlrev_b32 v44, 16, v18
    v_and_b32 v45, 0xffff0000, v18
    v_lshlrev_b32 v46, 16, v19
    v_and_b32 v47, 0xffff0000, v19
    v_lshlrev_b32 v48, 16, v20
    v_and_b32 v49, 0xffff0000, v20
    v_lshlrev_b32 v50, 16, v21
    v_and_b32 v51, 0xffff0000, v21
    v_lshlrev_b32 v52, 16, v22
    v_and_b32 v53, 0xffff0000, v22
    v_lshlrev_b32 v54, 16, v23
    v_and_b32 v55, 0xffff0000, v23
    v_lshlrev_b32 v56, 16, v24
    v_and_b32 v57, 0xffff0000, v24
    v_lshlrev_b32 v58, 16, v25
    v_and_b32 v59, 0xffff0000, v25
    v_lshlrev_b32 v60, 16, v26
    v_and_b32 v61, 0xffff0000, v26
    v_lshlrev_b32 v62, 16, v27
    v_and_b32 v63, 0xffff0000, v27
    v_lshlrev_b32 v64, 16, v28
    v_and_b32 v65, 0xffff0000, v28
    v_lshlrev_b32 v66, 16, v29
    v_and_b32 v67, 0xffff0000, v29
    v_lshlrev_b32 v68, 16, v30
    v_and_b32 v69, 0xffff0000, v30
    v_lshlrev_b32 v70, 16, v31
    v_and_b32 v71, 0xffff0000, v31
    v_lshlrev_b32 v72, 16, v32
    v_and_b32 v73, 0xffff0000, v32
    v_lshlrev_b32 v74, 16, v33
    v_and_b32 v75, 0xffff0000, v33
    v_lshlrev_b32 v76, 16, v34
    v_and_b32 v77, 0xffff0000, v34
    v_lshlrev_b32 v78, 16, v35
    v_and_b32 v79, 0xffff0000, v35
    v_add_f32 v10, v40, v44
    v_add_f32 v11, v41, v45
    v_add_f32 v12, v42, v46
    v_add_f32 v13, v43, v47
    v_add_f32 v10, v10, v48
    v_add_f32 v11, v11, v49
    v_add_f32 v12, v12, v50
    v_add_f32 v13, v13, v51
    v_add_f32 v10, v10, v52
    v_add_f32 v11, v11, v53
    v_add_f32 v12, v12, v54
    v_add_f32 v13, v13, v55
    v_add_f32 v10, v10, v56
    v_add_f32 v11, v11, v57
    v_add_f32 v12, v12, v58
    v_add_f32 v13, v13, v59
    v_add_f32 v10, v10, v60
    v_add_f32 v11, v11, v61
    v_add_f32 v12, v12, v62
    v_add_f32 v13, v13, v63
    v_add_f32 v10, v10, v64
    v_add_f32 v11, v11, v65
    v_add_f32 v12, v12, v66
    v_add_f32 v13, v13, v67
    v_add_f32 v10, v10, v68
    v_add_f32 v11, v11, v69
    v_add_f32 v12, v12, v70
    v_add_f32 v13, v13, v71
    v_add_f32 v10, v10, v72
    v_add_f32 v11, v11, v73
    v_add_f32 v12, v12, v74
    v_add_f32 v13, v13, v75
    v_add_f32 v10, v10, v76
    v_add_f32 v11, v11, v77
    v_add_f32 v12, v12, v78
    v_add_f32 v13, v13, v79
    v_add_f32 v10, v10, v11
    v_add_f32 v12, v12, v13
    v_add_f32 v10, v10, v12
    s_nop 1
    v_add_f32_dpp v10, v10, v10 row_ror:8 row_mask:0xf bank_mask:0xf
    s_nop 1
    v_add_f32_dpp v10, v10, v10 row_ror:4 row_mask:0xf bank_mask:0xf
    s_nop 1
    v_add_f32_dpp v10, v10, v10 row_ror:2 row_mask:0xf bank_mask:0xf
    s_nop 1
    v_add_f32_dpp v10, v10, v10 row_ror:1 row_mask:0xf bank_mask:0xf
    v_mul_f32 v14, 0x3acccccd, v10
    v_sub_f32 v80, v40, v14
    v_mul_f32 v80, v80, v80
    v_sub_f32 v81, v41, v14
    v_mul_f32 v81, v81, v81
    v_sub_f32 v82, v42, v14
    v_mul_f32 v82, v82, v82
    v_sub_f32 v83, v43, v14
    v_mul_f32 v83, v83, v83
    v_sub_f32 v84, v44, v14
    v_mul_f32 v84, v84, v84
    v_sub_f32 v85, v45, v14
    v_mul_f32 v85, v85, v85
    v_sub_f32 v86, v46, v14
    v_mul_f32 v86, v86, v86
    v_sub_f32 v87, v47, v14
    v_mul_f32 v87, v87, v87
    v_sub_f32 v88, v48, v14
    v_mul_f32 v88, v88, v88
    v_sub_f32 v89, v49, v14
    v_mul_f32 v89, v89, v89
    v_sub_f32 v90, v50, v14
    v_mul_f32 v90, v90, v90
    v_sub_f32 v91, v51, v14
    v_mul_f32 v91, v91, v91
    v_sub_f32 v92, v52, v14
    v_mul_f32 v92, v92, v92
    v_sub_f32 v93, v53, v14
    v_mul_f32 v93, v93, v93
    v_sub_f32 v94, v54, v14
    v_mul_f32 v94, v94, v94
    v_sub_f32 v95, v55, v14
    v_mul_f32 v95, v95, v95
    v_sub_f32 v96, v56, v14
    v_mul_f32 v96, v96, v96
    v_sub_f32 v97, v57, v14
    v_mul_f32 v97, v97, v97
    v_sub_f32 v98, v58, v14
    v_mul_f32 v98, v98, v98
    v_sub_f32 v99, v59, v14
    v_mul_f32 v99, v99, v99
    v_sub_f32 v100, v60, v14
    v_mul_f32 v100, v100, v100
    v_sub_f32 v101, v61, v14
    v_mul_f32 v101, v101, v101
    v_sub_f32 v102, v62, v14
    v_mul_f32 v102, v102, v102
    v_sub_f32 v103, v63, v14
    v_mul_f32 v103, v103, v103
    v_sub_f32 v104, v64, v14
    v_mul_f32 v104, v104, v104
    v_sub_f32 v105, v65, v14
    v_mul_f32 v105, v105, v105
    v_sub_f32 v106, v66, v14
    v_mul_f32 v106, v106, v106
    v_sub_f32 v107, v67, v14
    v_mul_f32 v107, v107, v107
    v_sub_f32 v108, v68, v14
    v_mul_f32 v108, v108, v108
    v_sub_f32 v109, v69, v14
    v_mul_f32 v109, v109, v109
    v_sub_f32 v110, v70, v14
    v_mul_f32 v110, v110, v110
    v_sub_f32 v111, v71, v14
    v_mul_f32 v111, v111, v111
    v_sub_f32 v112, v72, v14
    v_mul_f32 v112, v112, v112
    v_sub_f32 v113, v73, v14
    v_mul_f32 v113, v113, v113
    v_sub_f32 v114, v74, v14
    v_mul_f32 v114, v114, v114
    v_sub_f32 v115, v75, v14
    v_mul_f32 v115, v115, v115
    v_sub_f32 v116, v76, v14
    v_mul_f32 v116, v116, v116
    v_sub_f32 v117, v77, v14
    v_mul_f32 v117, v117, v117
    v_sub_f32 v118, v78, v14
    v_mul_f32 v118, v118, v118
    v_sub_f32 v119, v79, v14
    v_mul_f32 v119, v119, v119
    v_add_f32 v10, v80, v84
    v_add_f32 v11, v81, v85
    v_add_f32 v12, v82, v86
    v_add_f32 v13, v83, v87
    v_add_f32 v10, v10, v88
    v_add_f32 v11, v11, v89
    v_add_f32 v12, v12, v90
    v_add_f32 v13, v13, v91
    v_add_f32 v10, v10, v92
    v_add_f32 v11, v11, v93
    v_add_f32 v12, v12, v94
    v_add_f32 v13, v13, v95
    v_add_f32 v10, v10, v96
    v_add_f32 v11, v11, v97
    v_add_f32 v12, v12, v98
    v_add_f32 v13, v13, v99
    v_add_f32 v10, v10, v100
    v_add_f32 v11, v11, v101
    v_add_f32 v12, v12, v102
    v_add_f32 v13, v13, v103
    v_add_f32 v10, v10, v104
    v_add_f32 v11, v11, v105
    v_add_f32 v12, v12, v106
    v_add_f32 v13, v13, v107
    v_add_f32 v10, v10, v108
    v_add_f32 v11, v11, v109
    v_add_f32 v12, v12, v110
    v_add_f32 v13, v13, v111
    v_add_f32 v10, v10, v112
    v_add_f32 v11, v11, v113
    v_add_f32 v12, v12, v114
    v_add_f32 v13, v13, v115
    v_add_f32 v10, v10, v116
    v_add_f32 v11, v11, v117
    v_add_f32 v12, v12, v118
    v_add_f32 v13, v13, v119
    v_add_f32 v10, v10, v11
    v_add_f32 v12, v12, v13
    v_add_f32 v10, v10, v12
    s_nop 1
    v_add_f32_dpp v10, v10, v10 row_ror:8 row_mask:0xf bank_mask:0xf
    s_nop 1
    v_add_f32_dpp v10, v10, v10 row_ror:4 row_mask:0xf bank_mask:0xf
    s_nop 1
    v_add_f32_dpp v10, v10, v10 row_ror:2 row_mask:0xf bank_mask:0xf
    s_nop 1
    v_add_f32_dpp v10, v10, v10 row_ror:1 row_mask:0xf bank_mask:0xf
    v_mul_f32 v10, 0x3acccccd, v10
    v_cvt_pk_bf16_f32 v10, v10, v14
    v_and_b32 v14, 0xffff0000, v10
    v_lshlrev_b32 v10, 16, v10
    v_add_f32 v10, 0x3727c5ac, v10
    v_cvt_pk_bf16_f32 v10, v10, v10
    v_lshlrev_b32 v10, 16, v10
    v_sqrt_f32 v10, v10
    s_nop 0
    v_cvt_pk_bf16_f32 v10, v10, v10
    v_lshlrev_b32 v10, 16, v10
    v_rcp_f32 v11, v10
    s_nop 0
    v_fma_f32 v12, -v10, v11, 2.0
    v_mul_f32 v11, v11, v12
    v_sub_f32 v40, v40, v14
    v_sub_f32 v41, v41, v14
    v_cvt_pk_bf16_f32 v16, v40, v41
    v_lshlrev_b32 v40, 16, v16
    v_and_b32 v41, 0xffff0000, v16
    v_mul_f32 v40, v40, v11
    v_mul_f32 v41, v41, v11
    v_cvt_pk_bf16_f32 v16, v40, v41
    v_sub_f32 v42, v42, v14
    v_sub_f32 v43, v43, v14
    v_cvt_pk_bf16_f32 v17, v42, v43
    v_lshlrev_b32 v42, 16, v17
    v_and_b32 v43, 0xffff0000, v17
    v_mul_f32 v42, v42, v11
    v_mul_f32 v43, v43, v11
    v_cvt_pk_bf16_f32 v17, v42, v43
    v_sub_f32 v44, v44, v14
    v_sub_f32 v45, v45, v14
    v_cvt_pk_bf16_f32 v18, v44, v45
    v_lshlrev_b32 v44, 16, v18
    v_and_b32 v45, 0xffff0000, v18
    v_mul_f32 v44, v44, v11
    v_mul_f32 v45, v45, v11
    v_cvt_pk_bf16_f32 v18, v44, v45
    v_sub_f32 v46, v46, v14
    v_sub_f32 v47, v47, v14
    v_cvt_pk_bf16_f32 v19, v46, v47
    v_lshlrev_b32 v46, 16, v19
    v_and_b32 v47, 0xffff0000, v19
    v_mul_f32 v46, v46, v11
    v_mul_f32 v47, v47, v11
    v_cvt_pk_bf16_f32 v19, v46, v47
    v_sub_f32 v48, v48, v14
    v_sub_f32 v49, v49, v14
    v_cvt_pk_bf16_f32 v20, v48, v49
    v_lshlrev_b32 v48, 16, v20
    v_and_b32 v49, 0xffff0000, v20
    v_mul_f32 v48, v48, v11
    v_mul_f32 v49, v49, v11
    v_cvt_pk_bf16_f32 v20, v48, v49
    v_sub_f32 v50, v50, v14
    v_sub_f32 v51, v51, v14
    v_cvt_pk_bf16_f32 v21, v50, v51
    v_lshlrev_b32 v50, 16, v21
    v_and_b32 v51, 0xffff0000, v21
    v_mul_f32 v50, v50, v11
    v_mul_f32 v51, v51, v11
    v_cvt_pk_bf16_f32 v21, v50, v51
    v_sub_f32 v52, v52, v14
    v_sub_f32 v53, v53, v14
    v_cvt_pk_bf16_f32 v22, v52, v53
    v_lshlrev_b32 v52, 16, v22
    v_and_b32 v53, 0xffff0000, v22
    v_mul_f32 v52, v52, v11
    v_mul_f32 v53, v53, v11
    v_cvt_pk_bf16_f32 v22, v52, v53
    v_sub_f32 v54, v54, v14
    v_sub_f32 v55, v55, v14
    v_cvt_pk_bf16_f32 v23, v54, v55
    v_lshlrev_b32 v54, 16, v23
    v_and_b32 v55, 0xffff0000, v23
    v_mul_f32 v54, v54, v11
    v_mul_f32 v55, v55, v11
    v_cvt_pk_bf16_f32 v23, v54, v55
    v_sub_f32 v56, v56, v14
    v_sub_f32 v57, v57, v14
    v_cvt_pk_bf16_f32 v24, v56, v57
    v_lshlrev_b32 v56, 16, v24
    v_and_b32 v57, 0xffff0000, v24
    v_mul_f32 v56, v56, v11
    v_mul_f32 v57, v57, v11
    v_cvt_pk_bf16_f32 v24, v56, v57
    v_sub_f32 v58, v58, v14
    v_sub_f32 v59, v59, v14
    v_cvt_pk_bf16_f32 v25, v58, v59
    v_lshlrev_b32 v58, 16, v25
    v_and_b32 v59, 0xffff0000, v25
    v_mul_f32 v58, v58, v11
    v_mul_f32 v59, v59, v11
    v_cvt_pk_bf16_f32 v25, v58, v59
    v_sub_f32 v60, v60, v14
    v_sub_f32 v61, v61, v14
    v_cvt_pk_bf16_f32 v26, v60, v61
    v_lshlrev_b32 v60, 16, v26
    v_and_b32 v61, 0xffff0000, v26
    v_mul_f32 v60, v60, v11
    v_mul_f32 v61, v61, v11
    v_cvt_pk_bf16_f32 v26, v60, v61
    v_sub_f32 v62, v62, v14
    v_sub_f32 v63, v63, v14
    v_cvt_pk_bf16_f32 v27, v62, v63
    v_lshlrev_b32 v62, 16, v27
    v_and_b32 v63, 0xffff0000, v27
    v_mul_f32 v62, v62, v11
    v_mul_f32 v63, v63, v11
    v_cvt_pk_bf16_f32 v27, v62, v63
    v_sub_f32 v64, v64, v14
    v_sub_f32 v65, v65, v14
    v_cvt_pk_bf16_f32 v28, v64, v65
    v_lshlrev_b32 v64, 16, v28
    v_and_b32 v65, 0xffff0000, v28
    v_mul_f32 v64, v64, v11
    v_mul_f32 v65, v65, v11
    v_cvt_pk_bf16_f32 v28, v64, v65
    v_sub_f32 v66, v66, v14
    v_sub_f32 v67, v67, v14
    v_cvt_pk_bf16_f32 v29, v66, v67
    v_lshlrev_b32 v66, 16, v29
    v_and_b32 v67, 0xffff0000, v29
    v_mul_f32 v66, v66, v11
    v_mul_f32 v67, v67, v11
    v_cvt_pk_bf16_f32 v29, v66, v67
    v_sub_f32 v68, v68, v14
    v_sub_f32 v69, v69, v14
    v_cvt_pk_bf16_f32 v30, v68, v69
    v_lshlrev_b32 v68, 16, v30
    v_and_b32 v69, 0xffff0000, v30
    v_mul_f32 v68, v68, v11
    v_mul_f32 v69, v69, v11
    v_cvt_pk_bf16_f32 v30, v68, v69
    v_sub_f32 v70, v70, v14
    v_sub_f32 v71, v71, v14
    v_cvt_pk_bf16_f32 v31, v70, v71
    v_lshlrev_b32 v70, 16, v31
    v_and_b32 v71, 0xffff0000, v31
    v_mul_f32 v70, v70, v11
    v_mul_f32 v71, v71, v11
    v_cvt_pk_bf16_f32 v31, v70, v71
    v_sub_f32 v72, v72, v14
    v_sub_f32 v73, v73, v14
    v_cvt_pk_bf16_f32 v32, v72, v73
    v_lshlrev_b32 v72, 16, v32
    v_and_b32 v73, 0xffff0000, v32
    v_mul_f32 v72, v72, v11
    v_mul_f32 v73, v73, v11
    v_cvt_pk_bf16_f32 v32, v72, v73
    v_sub_f32 v74, v74, v14
    v_sub_f32 v75, v75, v14
    v_cvt_pk_bf16_f32 v33, v74, v75
    v_lshlrev_b32 v74, 16, v33
    v_and_b32 v75, 0xffff0000, v33
    v_mul_f32 v74, v74, v11
    v_mul_f32 v75, v75, v11
    v_cvt_pk_bf16_f32 v33, v74, v75
    v_sub_f32 v76, v76, v14
    v_sub_f32 v77, v77, v14
    v_cvt_pk_bf16_f32 v34, v76, v77
    v_lshlrev_b32 v76, 16, v34
    v_and_b32 v77, 0xffff0000, v34
    v_mul_f32 v76, v76, v11
    v_mul_f32 v77, v77, v11
    v_cvt_pk_bf16_f32 v34, v76, v77
    v_sub_f32 v78, v78, v14
    v_sub_f32 v79, v79, v14
    v_cvt_pk_bf16_f32 v35, v78, v79
    v_lshlrev_b32 v78, 16, v35
    v_and_b32 v79, 0xffff0000, v35
    v_mul_f32 v78, v78, v11
    v_mul_f32 v79, v79, v11
    v_cvt_pk_bf16_f32 v35, v78, v79
    buffer_store_dwordx4 v[16:19], v7, s[28:31], s6 offen sc1
    s_add_u32 s6, s6, 8192
    buffer_store_dwordx4 v[20:23], v7, s[28:31], s6 offen sc1
    s_add_u32 s6, s6, 8192
    buffer_store_dwordx4 v[24:27], v7, s[28:31], s6 offen sc1
    s_add_u32 s6, s6, 8192
    buffer_store_dwordx4 v[28:31], v7, s[28:31], s6 offen sc1
    s_add_u32 s6, s6, 8192
    buffer_store_dwordx4 v[32:35], v7, s[28:31], s6 offen sc1
    ds_write_b16 v9, v16 offset:0
    ds_write_b16_d16_hi v9, v16 offset:36
    ds_write_b16 v9, v17 offset:72
    ds_write_b16_d16_hi v9, v17 offset:108
    ds_write_b16 v9, v18 offset:144
    ds_write_b16_d16_hi v9, v18 offset:180
    ds_write_b16 v9, v19 offset:216
    ds_write_b16_d16_hi v9, v19 offset:252
    ds_write_b16 v9, v20 offset:4608
    ds_write_b16_d16_hi v9, v20 offset:4644
    ds_write_b16 v9, v21 offset:4680
    ds_write_b16_d16_hi v9, v21 offset:4716
    ds_write_b16 v9, v22 offset:4752
    ds_write_b16_d16_hi v9, v22 offset:4788
    ds_write_b16 v9, v23 offset:4824
    ds_write_b16_d16_hi v9, v23 offset:4860
    ds_write_b16 v9, v24 offset:9216
    ds_write_b16_d16_hi v9, v24 offset:9252
    ds_write_b16 v9, v25 offset:9288
    ds_write_b16_d16_hi v9, v25 offset:9324
    ds_write_b16 v9, v26 offset:9360
    ds_write_b16_d16_hi v9, v26 offset:9396
    ds_write_b16 v9, v27 offset:9432
    ds_write_b16_d16_hi v9, v27 offset:9468
    ds_write_b16 v9, v28 offset:13824
    ds_write_b16_d16_hi v9, v28 offset:13860
    ds_write_b16 v9, v29 offset:13896
    ds_write_b16_d16_hi v9, v29 offset:13932
    ds_write_b16 v9, v30 offset:13968
    ds_write_b16_d16_hi v9, v30 offset:14004
    ds_write_b16 v9, v31 offset:14040
    ds_write_b16_d16_hi v9, v31 offset:14076
    ds_write_b16 v9, v32 offset:18432
    ds_write_b16_d16_hi v9, v32 offset:18468
    ds_write_b16 v9, v33 offset:18504
    ds_write_b16_d16_hi v9, v33 offset:18540
    ds_write_b16 v9, v34 offset:18576
    ds_write_b16_d16_hi v9, v34 offset:18612
    ds_write_b16 v9, v35 offset:18648
    ds_write_b16_d16_hi v9, v35 offset:18684
    v_lshrrev_b32 v10, 1, v0
    v_and_b32 v11, 1, v0
    v_mul_u32_u24 v12, 36, v10
    v_lshl_add_u32 v12, v11, 4, v12
    v_lshlrev_b32 v13, 4, v0
    s_mul_i32 s6, s2, 20480
    s_add_u32 s6, s6, 2621440
    s_waitcnt lgkmcnt(0)
    s_barrier
    ds_read2_b32 v[40:41], v12 offset0:0 offset1:1
    ds_read2_b32 v[42:43], v12 offset0:2 offset1:3
    v_add_u32 v12, 4096, v12
    ds_read2_b32 v[44:45], v12 offset0:128 offset1:129
    ds_read2_b32 v[46:47], v12 offset0:130 offset1:131
    v_add_u32 v12, 5120, v12
    ds_read2_b32 v[48:49], v12 offset0:0 offset1:1
    ds_read2_b32 v[50:51], v12 offset0:2 offset1:3
    v_add_u32 v12, 4096, v12
    ds_read2_b32 v[52:53], v12 offset0:128 offset1:129
    ds_read2_b32 v[54:55], v12 offset0:130 offset1:131
    v_add_u32 v12, 5120, v12
    ds_read2_b32 v[56:57], v12 offset0:0 offset1:1
    ds_read2_b32 v[58:59], v12 offset0:2 offset1:3
    s_waitcnt lgkmcnt(8)
    buffer_store_dwordx4 v[40:43], v13, s[28:31], s6 offen sc1
    s_add_u32 s6, s6, 4096
    s_waitcnt lgkmcnt(6)
    buffer_store_dwordx4 v[44:47], v13, s[28:31], s6 offen sc1
    s_add_u32 s6, s6, 4096
    s_waitcnt lgkmcnt(4)
    buffer_store_dwordx4 v[48:51], v13, s[28:31], s6 offen sc1
    s_add_u32 s6, s6, 4096
    s_waitcnt lgkmcnt(2)
    buffer_store_dwordx4 v[52:55], v13, s[28:31], s6 offen sc1
    s_add_u32 s6, s6, 4096
    s_waitcnt lgkmcnt(0)
    buffer_store_dwordx4 v[56:59], v13, s[28:31], s6 offen sc1
    s_endpgm
prep_wt:
    s_setprio 3
    s_load_dwordx2 s[40:41], s[0:1], 64
    s_load_dwordx2 s[42:43], s[0:1], 80
    s_sub_u32 s4, s2, 768
    s_lshl_b32 s4, s4, 2
    s_add_u32 s4, s4, s3
    s_waitcnt lgkmcnt(0)
    s_cmp_ge_u32 s4, 270
    s_cselect_b32 s40, s42, s40
    s_cselect_b32 s41, s43, s41
    s_mov_b32 s5, 3456
    s_mov_b32 s7, 159072863
    s_mov_b32 s34, 5242880
    s_cselect_b32 s5, 1280, s5
    s_cselect_b32 s6, 10, 27
    s_cselect_b32 s7, 429496730, s7
    s_cselect_b32 s32, 270, 0
    s_cselect_b32 s33, 108, 40
    s_cselect_b32 s34, 7454720, s34
    s_mov_b32 s8, s40
    s_and_b32 s9, s41, 0xffff
    s_mov_b32 s10, 2211840
    s_mov_b32 s11, 0x00020000
    s_mov_b32 s28, s56
    s_and_b32 s29, s57, 0xffff
    s_mov_b32 s30, 268435456
    s_mov_b32 s31, 0x00020000
    s_sub_u32 s32, s4, s32
    s_lshl_b32 s32, s32, 2
    v_lshrrev_b32 v3, 3, v2
    v_and_b32 v4, 7, v2
    v_mul_lo_u32 v5, v3, s5
    v_lshl_add_u32 v5, v4, 4, v5
    s_lshl_b32 s35, s5, 3
    s_mul_i32 s36, s3, 9216
    v_mul_u32_u24 v6, 144, v3
    v_lshl_add_u32 v6, v4, 4, v6
    v_add_u32 v6, s36, v6
    v_and_b32 v7, 31, v2
    v_lshrrev_b32 v8, 5, v2
    v_mul_u32_u24 v8, 1152, v8
    v_lshl_add_u32 v8, v7, 1, v8
    v_add_u32 v8, s36, v8
    v_lshlrev_b32 v9, 4, v2
    s_sleep 24
    s_add_u32 s37, s32, 0
    s_mul_hi_u32 s38, s37, s7
    s_mul_i32 s39, s38, s6
    s_sub_u32 s39, s37, s39
    s_lshl_b32 s44, s38, 4
    s_mul_i32 s44, s44, s5
    s_lshl_b32 s45, s39, 7
    s_add_u32 s44, s44, s45
    buffer_load_dwordx4 v[16:19], v5, s[8:11], s44 offen
    s_add_u32 s44, s44, s35
    buffer_load_dwordx4 v[20:23], v5, s[8:11], s44 offen
    s_lshl_b32 s45, s39, 1
    s_mul_i32 s45, s45, s33
    s_add_u32 s45, s45, s38
    s_lshl_b32 s45, s45, 10
    s_add_u32 s48, s45, s34
    s_add_u32 s37, s32, 1
    s_mul_hi_u32 s38, s37, s7
    s_mul_i32 s39, s38, s6
    s_sub_u32 s39, s37, s39
    s_lshl_b32 s44, s38, 4
    s_mul_i32 s44, s44, s5
    s_lshl_b32 s45, s39, 7
    s_add_u32 s44, s44, s45
    buffer_load_dwordx4 v[24:27], v5, s[8:11], s44 offen
    s_add_u32 s44, s44, s35
    buffer_load_dwordx4 v[28:31], v5, s[8:11], s44 offen
    s_lshl_b32 s45, s39, 1
    s_mul_i32 s45, s45, s33
    s_add_u32 s45, s45, s38
    s_lshl_b32 s45, s45, 10
    s_add_u32 s49, s45, s34
    s_add_u32 s37, s32, 2
    s_mul_hi_u32 s38, s37, s7
    s_mul_i32 s39, s38, s6
    s_sub_u32 s39, s37, s39
    s_lshl_b32 s44, s38, 4
    s_mul_i32 s44, s44, s5
    s_lshl_b32 s45, s39, 7
    s_add_u32 s44, s44, s45
    buffer_load_dwordx4 v[32:35], v5, s[8:11], s44 offen
    s_add_u32 s44, s44, s35
    buffer_load_dwordx4 v[36:39], v5, s[8:11], s44 offen
    s_lshl_b32 s45, s39, 1
    s_mul_i32 s45, s45, s33
    s_add_u32 s45, s45, s38
    s_lshl_b32 s45, s45, 10
    s_add_u32 s50, s45, s34
    s_add_u32 s37, s32, 3
    s_mul_hi_u32 s38, s37, s7
    s_mul_i32 s39, s38, s6
    s_sub_u32 s39, s37, s39
    s_lshl_b32 s44, s38, 4
    s_mul_i32 s44, s44, s5
    s_lshl_b32 s45, s39, 7
    s_add_u32 s44, s44, s45
    buffer_load_dwordx4 v[40:43], v5, s[8:11], s44 offen
    s_add_u32 s44, s44, s35
    buffer_load_dwordx4 v[44:47], v5, s[8:11], s44 offen
    s_lshl_b32 s45, s39, 1
    s_mul_i32 s45, s45, s33
    s_add_u32 s45, s45, s38
    s_lshl_b32 s45, s45, 10
    s_add_u32 s51, s45, s34
    s_lshl_b32 s33, s33, 10
    s_waitcnt vmcnt(6)
    ds_write_b128 v6, v[16:19] offset:0
    ds_write_b128 v6, v[20:23] offset:1152
    s_waitcnt vmcnt(4)
    ds_write_b128 v6, v[24:27] offset:2304
    ds_write_b128 v6, v[28:31] offset:3456
    s_waitcnt vmcnt(2)
    ds_write_b128 v6, v[32:35] offset:4608
    ds_write_b128 v6, v[36:39] offset:5760
    s_waitcnt vmcnt(0)
    ds_write_b128 v6, v[40:43] offset:6912
    ds_write_b128 v6, v[44:47] offset:8064
    s_waitcnt lgkmcnt(0)
    ds_read_u16 v48, v8 offset:0
    ds_read_u16 v49, v8 offset:144
    ds_read_u16 v50, v8 offset:288
    ds_read_u16 v51, v8 offset:432
    ds_read_u16 v52, v8 offset:576
    ds_read_u16 v53, v8 offset:720
    ds_read_u16 v54, v8 offset:864
    ds_read_u16 v55, v8 offset:1008
    ds_read_u16 v64, v8 offset:64
    ds_read_u16 v65, v8 offset:208
    ds_read_u16 v66, v8 offset:352
    ds_read_u16 v67, v8 offset:496
    ds_read_u16 v68, v8 offset:640
    ds_read_u16 v69, v8 offset:784
    ds_read_u16 v70, v8 offset:928
    ds_read_u16 v71, v8 offset:1072
    s_waitcnt lgkmcnt(0)
    v_lshl_or_b32 v112, v49, 16, v48
    v_lshl_or_b32 v113, v51, 16, v50
    v_lshl_or_b32 v114, v53, 16, v52
    v_lshl_or_b32 v115, v55, 16, v54
    buffer_store_dwordx4 v[112:115], v9, s[28:31], s48 offen sc1
    v_lshl_or_b32 v116, v65, 16, v64
    v_lshl_or_b32 v117, v67, 16, v66
    v_lshl_or_b32 v118, v69, 16, v68
    v_lshl_or_b32 v119, v71, 16, v70
    s_add_u32 s48, s48, s33
    buffer_store_dwordx4 v[116:119], v9, s[28:31], s48 offen sc1
    s_nop 1
    ds_read_u16 v80, v8 offset:2304
    ds_read_u16 v81, v8 offset:2448
    ds_read_u16 v82, v8 offset:2592
    ds_read_u16 v83, v8 offset:2736
    ds_read_u16 v84, v8 offset:2880
    ds_read_u16 v85, v8 offset:3024
    ds_read_u16 v86, v8 offset:3168
    ds_read_u16 v87, v8 offset:3312
    ds_read_u16 v96, v8 offset:2368
    ds_read_u16 v97, v8 offset:2512
    ds_read_u16 v98, v8 offset:2656
    ds_read_u16 v99, v8 offset:2800
    ds_read_u16 v100, v8 offset:2944
    ds_read_u16 v101, v8 offset:3088
    ds_read_u16 v102, v8 offset:3232
    ds_read_u16 v103, v8 offset:3376
    s_waitcnt lgkmcnt(0)
    v_lshl_or_b32 v112, v81, 16, v80
    v_lshl_or_b32 v113, v83, 16, v82
    v_lshl_or_b32 v114, v85, 16, v84
    v_lshl_or_b32 v115, v87, 16, v86
    buffer_store_dwordx4 v[112:115], v9, s[28:31], s49 offen sc1
    v_lshl_or_b32 v116, v97, 16, v96
    v_lshl_or_b32 v117, v99, 16, v98
    v_lshl_or_b32 v118, v101, 16, v100
    v_lshl_or_b32 v119, v103, 16, v102
    s_add_u32 s49, s49, s33
    buffer_store_dwordx4 v[116:119], v9, s[28:31], s49 offen sc1
    s_nop 1
    ds_read_u16 v48, v8 offset:4608
    ds_read_u16 v49, v8 offset:4752
    ds_read_u16 v50, v8 offset:4896
    ds_read_u16 v51, v8 offset:5040
    ds_read_u16 v52, v8 offset:5184
    ds_read_u16 v53, v8 offset:5328
    ds_read_u16 v54, v8 offset:5472
    ds_read_u16 v55, v8 offset:5616
    ds_read_u16 v64, v8 offset:4672
    ds_read_u16 v65, v8 offset:4816
    ds_read_u16 v66, v8 offset:4960
    ds_read_u16 v67, v8 offset:5104
    ds_read_u16 v68, v8 offset:5248
    ds_read_u16 v69, v8 offset:5392
    ds_read_u16 v70, v8 offset:5536
    ds_read_u16 v71, v8 offset:5680
    s_waitcnt lgkmcnt(0)
    v_lshl_or_b32 v112, v49, 16, v48
    v_lshl_or_b32 v113, v51, 16, v50
    v_lshl_or_b32 v114, v53, 16, v52
    v_lshl_or_b32 v115, v55, 16, v54
    buffer_store_dwordx4 v[112:115], v9, s[28:31], s50 offen sc1
    v_lshl_or_b32 v116, v65, 16, v64
    v_lshl_or_b32 v117, v67, 16, v66
    v_lshl_or_b32 v118, v69, 16, v68
    v_lshl_or_b32 v119, v71, 16, v70
    s_add_u32 s50, s50, s33
    buffer_store_dwordx4 v[116:119], v9, s[28:31], s50 offen sc1
    s_nop 1
    ds_read_u16 v80, v8 offset:6912
    ds_read_u16 v81, v8 offset:7056
    ds_read_u16 v82, v8 offset:7200
    ds_read_u16 v83, v8 offset:7344
    ds_read_u16 v84, v8 offset:7488
    ds_read_u16 v85, v8 offset:7632
    ds_read_u16 v86, v8 offset:7776
    ds_read_u16 v87, v8 offset:7920
    ds_read_u16 v96, v8 offset:6976
    ds_read_u16 v97, v8 offset:7120
    ds_read_u16 v98, v8 offset:7264
    ds_read_u16 v99, v8 offset:7408
    ds_read_u16 v100, v8 offset:7552
    ds_read_u16 v101, v8 offset:7696
    ds_read_u16 v102, v8 offset:7840
    ds_read_u16 v103, v8 offset:7984
    s_waitcnt lgkmcnt(0)
    v_lshl_or_b32 v112, v81, 16, v80
    v_lshl_or_b32 v113, v83, 16, v82
    v_lshl_or_b32 v114, v85, 16, v84
    v_lshl_or_b32 v115, v87, 16, v86
    buffer_store_dwordx4 v[112:115], v9, s[28:31], s51 offen sc1
    v_lshl_or_b32 v116, v97, 16, v96
    v_lshl_or_b32 v117, v99, 16, v98
    v_lshl_or_b32 v118, v101, 16, v100
    v_lshl_or_b32 v119, v103, 16, v102
    s_add_u32 s51, s51, s33
    buffer_store_dwordx4 v[116:119], v9, s[28:31], s51 offen sc1
prep_end:
    s_endpgm
.section .rodata,"a"
.p2align 6
.amdhsa_kernel prep_kernel
  .amdhsa_next_free_vgpr 128
  .amdhsa_next_free_sgpr 96
  .amdhsa_accum_offset 128
  .amdhsa_group_segment_fixed_size 0
  .amdhsa_kernarg_size 112
  .amdhsa_user_sgpr_count 2
  .amdhsa_user_sgpr_kernarg_segment_ptr 1
  .amdhsa_system_sgpr_workgroup_id_x 1
.end_amdhsa_kernel
.text
.globl mid_kernel
.p2align 8
.type mid_kernel,@function
mid_kernel:
    s_cmp_ge_u32 s2, 896
    s_cbranch_scc1 mid_end
mid_body:
    s_mov_b32 s90, s2
    s_load_dwordx2 s[56:57], s[0:1], 104
    s_load_dwordx2 s[58:59], s[0:1], 72
    s_load_dwordx2 s[60:61], s[0:1], 48
    v_lshrrev_b32 v1, 6, v0
    v_and_b32 v2, 63, v0
    s_nop 0
    v_readfirstlane_b32 s3, v1
    s_waitcnt lgkmcnt(0)
    s_mov_b32 s28, s56
    s_and_b32 s29, s57, 0xffff
    s_mov_b32 s30, 268435456
    s_mov_b32 s31, 0x00020000
    s_cmp_ge_u32 s2, 256
    s_cbranch_scc1 mid_conv
    s_mov_b32 s8, s58
    s_and_b32 s9, s59, 0xffff
    s_mov_b32 s10, 3456
    s_mov_b32 s11, 0x00020000
    s_cmp_lg_u32 s3, 0
    s_cbranch_scc1 mcl_w
    s_getreg_b32 s20, hwreg(HW_REG_XCC_ID)
    s_and_b32 s20, s20, 7
    s_mov_b32 s21, 0
    s_mov_b64 s[22:23], exec
    s_mov_b64 exec, 1
    v_mov_b32 v12, 1
mcl_l:
    s_lshl_b32 s24, s20, 12
    s_add_u32 s24, s24, 24117248
    v_mov_b32 v13, 0
    v_mov_b32 v14, v12
    buffer_atomic_add v14, v13, s[28:31], s24 offen sc0 sc1
    s_waitcnt vmcnt(0)
    v_readfirstlane_b32 s25, v14
    s_cmp_lt_u32 s25, 32
    s_cbranch_scc1 mcl_f
    s_add_u32 s20, s20, 1
    s_and_b32 s20, s20, 7
    s_add_u32 s21, s21, 1
    s_cmp_lt_u32 s21, 8
    s_cbranch_scc1 mcl_l
    s_mov_b32 s25, 0
mcl_f:
    s_mul_i32 s20, s20, 32
    s_add_u32 s20, s20, s25
    v_mov_b32 v14, s20
    v_mov_b32 v13, 35840
    ds_write_b32 v13, v14
    s_mov_b64 exec, s[22:23]
    s_waitcnt lgkmcnt(0)
mcl_w:
    s_barrier
    v_mov_b32 v13, 35840
    ds_read_b32 v14, v13
    s_waitcnt lgkmcnt(0)
    v_readfirstlane_b32 s2, v14
    s_mov_b32 s90, s2
    s_lshr_b32 s5, s2, 6
    s_lshl_b32 s5, s5, 2
    s_bfe_u32 s6, s2, 0x20003
    s_add_u32 s5, s5, s6
    s_bfe_u32 s4, s2, 0x10005
    s_lshl_b32 s4, s4, 3
    s_and_b32 s6, s2, 7
    s_add_u32 s4, s4, s6
    s_lshl_b32 s88, s4, 2
    s_mul_i32 s6, s4, 7
    s_sub_u32 s7, s4, 12
    s_cmp_lt_u32 s4, 12
    s_cselect_b32 s7, 0, s7
    s_cselect_b32 s26, 7, 6
    s_sub_u32 s4, s6, s7
    v_and_b32 v3, 15, v2
    v_lshrrev_b32 v4, 4, v2
    v_lshrrev_b32 v5, 1, v4
    v_and_b32 v6, 1, v4
    v_lshlrev_b32 v7, 4, v3
    v_lshl_add_u32 v7, v5, 10, v7
    v_lshl_add_u32 v7, v6, 9, v7
    v_mov_b32 v8, v7
    s_add_u32 s6, s3, 0
    s_min_u32 s6, s6, 6
    s_lshl_b32 s42, s6, 10
    s_add_u32 s6, s6, s4
    s_min_u32 s6, s6, 107
    s_lshr_b32 s40, s6, 1
    s_mul_i32 s40, s40, 40960
    s_and_b32 s6, s6, 1
    s_lshl_b32 s6, s6, 8
    s_add_u32 s40, s40, s6
    s_add_u32 s40, s40, 5242880
    s_add_u32 s6, s3, 4
    s_min_u32 s6, s6, 6
    s_lshl_b32 s43, s6, 10
    s_add_u32 s6, s6, s4
    s_min_u32 s6, s6, 107
    s_lshr_b32 s41, s6, 1
    s_mul_i32 s41, s41, 40960
    s_and_b32 s6, s6, 1
    s_lshl_b32 s6, s6, 8
    s_add_u32 s41, s41, s6
    s_add_u32 s41, s41, 5242880
    s_lshl_b32 s6, s5, 2
    s_add_u32 s27, s6, s3
    s_mul_i32 s44, s27, 40960
    s_add_u32 s44, s44, 0
    v_lshlrev_b32 v9, 4, v2
    s_add_u32 m0, s42, 0
    s_nop 0
    buffer_load_dwordx4 v7, s[28:31], s40 offen lds
    s_add_u32 m0, s43, 0
    s_nop 0
    buffer_load_dwordx4 v7, s[28:31], s41 offen lds
    v_add_u32 v7, 2048, v7
    buffer_load_dwordx4 v[40:43], v8, s[28:31], s44 offen
    buffer_load_dwordx4 v[44:47], v8, s[28:31], s44 offen offset:256
    v_add_u32 v8, 2048, v8
    s_add_u32 m0, s42, 7168
    s_nop 0
    buffer_load_dwordx4 v7, s[28:31], s40 offen lds
    s_add_u32 m0, s43, 7168
    s_nop 0
    buffer_load_dwordx4 v7, s[28:31], s41 offen lds
    v_add_u32 v7, 2048, v7
    buffer_load_dwordx4 v[48:51], v8, s[28:31], s44 offen
    buffer_load_dwordx4 v[52:55], v8, s[28:31], s44 offen offset:256
    v_add_u32 v8, 2048, v8
    s_add_u32 m0, s42, 14336
    s_nop 0
    buffer_load_dwordx4 v7, s[28:31], s40 offen lds
    s_add_u32 m0, s43, 14336
    s_nop 0
    buffer_load_dwordx4 v7, s[28:31], s41 offen lds
    v_add_u32 v7, 2048, v7
    buffer_load_dwordx4 v[56:59], v8, s[28:31], s44 offen
    buffer_load_dwordx4 v[60:63], v8, s[28:31], s44 offen offset:256
    v_add_u32 v8, 2048, v8
    s_add_u32 m0, s42, 21504
    s_nop 0
    buffer_load_dwordx4 v7, s[28:31], s40 offen lds
    s_add_u32 m0, s43, 21504
    s_nop 0
    buffer_load_dwordx4 v7, s[28:31], s41 offen lds
    v_add_u32 v7, 2048, v7
    buffer_load_dwordx4 v[64:67], v8, s[28:31], s44 offen
    buffer_load_dwordx4 v[68:71], v8, s[28:31], s44 offen offset:256
    v_add_u32 v8, 2048, v8
    s_lshl_b32 s6, s4, 5
    v_lshl_add_u32 v10, v4, 3, s6
    v_mov_b32 v72, 0
    v_mov_b32 v73, 0
    v_mov_b32 v74, 0
    v_mov_b32 v75, 0
    v_mov_b32 v76, 0
    v_mov_b32 v77, 0
    v_mov_b32 v78, 0
    v_mov_b32 v79, 0
    v_mov_b32 v80, 0
    v_mov_b32 v81, 0
    v_mov_b32 v82, 0
    v_mov_b32 v83, 0
    v_mov_b32 v84, 0
    v_mov_b32 v85, 0
    v_mov_b32 v86, 0
    v_mov_b32 v87, 0
    v_mov_b32 v88, 0
    v_mov_b32 v89, 0
    v_mov_b32 v90, 0
    v_mov_b32 v91, 0
    v_mov_b32 v92, 0
    v_mov_b32 v93, 0
    v_mov_b32 v94, 0
    v_mov_b32 v95, 0
    v_mov_b32 v96, 0
    v_mov_b32 v97, 0
    v_mov_b32 v98, 0
    v_mov_b32 v99, 0
    v_mov_b32 v100, 0
    v_mov_b32 v101, 0
    v_mov_b32 v102, 0
    v_mov_b32 v103, 0
    v_mov_b32 v104, 0
    v_mov_b32 v105, 0
    v_mov_b32 v106, 0
    v_mov_b32 v107, 0
    v_mov_b32 v108, 0
    v_mov_b32 v109, 0
    v_mov_b32 v110, 0
    v_mov_b32 v111, 0
    v_mov_b32 v112, 0
    v_mov_b32 v113, 0
    v_mov_b32 v114, 0
    v_mov_b32 v115, 0
    v_mov_b32 v116, 0
    v_mov_b32 v117, 0
    v_mov_b32 v118, 0
    v_mov_b32 v119, 0
    v_mov_b32 v120, 0
    v_mov_b32 v121, 0
    v_mov_b32 v122, 0
    v_mov_b32 v123, 0
    v_mov_b32 v124, 0
    v_mov_b32 v125, 0
    v_mov_b32 v126, 0
    v_mov_b32 v127, 0
    s_waitcnt vmcnt(14)
    s_barrier
    ds_read_b128 v[16:19], v9 offset:0
    ds_read_b128 v[20:23], v9 offset:1024
    ds_read_b128 v[24:27], v9 offset:2048
    ds_read_b128 v[28:31], v9 offset:3072
    ds_read_b128 v[32:35], v9 offset:4096
    ds_read_b128 v[36:39], v9 offset:5120
    s_waitcnt vmcnt(10)
    s_barrier
    s_add_u32 m0, s42, 28672
    s_nop 0
    buffer_load_dwordx4 v7, s[28:31], s40 offen lds
    s_add_u32 m0, s43, 28672
    s_nop 0
    buffer_load_dwordx4 v7, s[28:31], s41 offen lds
    v_add_u32 v7, 2048, v7
    s_waitcnt lgkmcnt(5)
    v_mfma_f32_16x16x32_bf16 v[72:75], v[16:19], v[40:43], v[72:75]
    v_mfma_f32_16x16x32_bf16 v[76:79], v[16:19], v[44:47], v[76:79]
    ds_read_b128 v[16:19], v9 offset:6144
    s_waitcnt lgkmcnt(5)
    v_mfma_f32_16x16x32_bf16 v[80:83], v[20:23], v[40:43], v[80:83]
    v_mfma_f32_16x16x32_bf16 v[84:87], v[20:23], v[44:47], v[84:87]
    ds_read_b128 v[20:23], v9 offset:7168
    s_waitcnt lgkmcnt(5)
    v_mfma_f32_16x16x32_bf16 v[88:91], v[24:27], v[40:43], v[88:91]
    v_mfma_f32_16x16x32_bf16 v[92:95], v[24:27], v[44:47], v[92:95]
    ds_read_b128 v[24:27], v9 offset:8192
    s_waitcnt lgkmcnt(5)
    v_mfma_f32_16x16x32_bf16 v[96:99], v[28:31], v[40:43], v[96:99]
    v_mfma_f32_16x16x32_bf16 v[100:103], v[28:31], v[44:47], v[100:103]
    ds_read_b128 v[28:31], v9 offset:9216
    s_waitcnt lgkmcnt(5)
    v_mfma_f32_16x16x32_bf16 v[104:107], v[32:35], v[40:43], v[104:107]
    v_mfma_f32_16x16x32_bf16 v[108:111], v[32:35], v[44:47], v[108:111]
    ds_read_b128 v[32:35], v9 offset:10240
    s_waitcnt lgkmcnt(5)
    v_mfma_f32_16x16x32_bf16 v[112:115], v[36:39], v[40:43], v[112:115]
    v_mfma_f32_16x16x32_bf16 v[116:119], v[36:39], v[44:47], v[116:119]
    ds_read_b128 v[36:39], v9 offset:11264
    s_waitcnt lgkmcnt(5)
    v_mfma_f32_16x16x32_bf16 v[120:123], v[16:19], v[40:43], v[120:123]
    v_mfma_f32_16x16x32_bf16 v[124:127], v[16:19], v[44:47], v[124:127]
    ds_read_b128 v[16:19], v9 offset:12288
    buffer_load_dwordx4 v[40:43], v8, s[28:31], s44 offen
    buffer_load_dwordx4 v[44:47], v8, s[28:31], s44 offen offset:256
    v_add_u32 v8, 2048, v8
    s_waitcnt vmcnt(10)
    s_barrier
    s_add_u32 m0, s42, 0
    s_nop 0
    buffer_load_dwordx4 v7, s[28:31], s40 offen lds
    s_add_u32 m0, s43, 0
    s_nop 0
    buffer_load_dwordx4 v7, s[28:31], s41 offen lds
    v_add_u32 v7, 2048, v7
    s_waitcnt lgkmcnt(5)
    v_mfma_f32_16x16x32_bf16 v[72:75], v[20:23], v[48:51], v[72:75]
    v_mfma_f32_16x16x32_bf16 v[76:79], v[20:23], v[52:55], v[76:79]
    ds_read_b128 v[20:23], v9 offset:13312
    s_waitcnt lgkmcnt(5)
    v_mfma_f32_16x16x32_bf16 v[80:83], v[24:27], v[48:51], v[80:83]
    v_mfma_f32_16x16x32_bf16 v[84:87], v[24:27], v[52:55], v[84:87]
    ds_read_b128 v[24:27], v9 offset:14336
    s_waitcnt lgkmcnt(5)
    v_mfma_f32_16x16x32_bf16 v[88:91], v[28:31], v[48:51], v[88:91]
    v_mfma_f32_16x16x32_bf16 v[92:95], v[28:31], v[52:55], v[92:95]
    ds_read_b128 v[28:31], v9 offset:15360
    s_waitcnt lgkmcnt(5)
    v_mfma_f32_16x16x32_bf16 v[96:99], v[32:35], v[48:51], v[96:99]
    v_mfma_f32_16x16x32_bf16 v[100:103], v[32:35], v[52:55], v[100:103]
    ds_read_b128 v[32:35], v9 offset:16384
    s_waitcnt lgkmcnt(5)
    v_mfma_f32_16x16x32_bf16 v[104:107], v[36:39], v[48:51], v[104:107]
    v_mfma_f32_16x16x32_bf16 v[108:111], v[36:39], v[52:55], v[108:111]
    ds_read_b128 v[36:39], v9 offset:17408
    s_waitcnt lgkmcnt(5)
    v_mfma_f32_16x16x32_bf16 v[112:115], v[16:19], v[48:51], v[112:115]
    v_mfma_f32_16x16x32_bf16 v[116:119], v[16:19], v[52:55], v[116:119]
    ds_read_b128 v[16:19], v9 offset:18432
    s_waitcnt lgkmcnt(5)
    v_mfma_f32_16x16x32_bf16 v[120:123], v[20:23], v[48:51], v[120:123]
    v_mfma_f32_16x16x32_bf16 v[124:127], v[20:23], v[52:55], v[124:127]
    ds_read_b128 v[20:23], v9 offset:19456
    buffer_load_dwordx4 v[48:51], v8, s[28:31], s44 offen
    buffer_load_dwordx4 v[52:55], v8, s[28:31], s44 offen offset:256
    v_add_u32 v8, 2048, v8
    s_waitcnt vmcnt(10)
    s_barrier
    s_add_u32 m0, s42, 7168
    s_nop 0
    buffer_load_dwordx4 v7, s[28:31], s40 offen lds
    s_add_u32 m0, s43, 7168
    s_nop 0
    buffer_load_dwordx4 v7, s[28:31], s41 offen lds
    v_add_u32 v7, 2048, v7
    s_waitcnt lgkmcnt(5)
    v_mfma_f32_16x16x32_bf16 v[72:75], v[24:27], v[56:59], v[72:75]
    v_mfma_f32_16x16x32_bf16 v[76:79], v[24:27], v[60:63], v[76:79]
    ds_read_b128 v[24:27], v9 offset:20480
    s_waitcnt lgkmcnt(5)
    v_mfma_f32_16x16x32_bf16 v[80:83], v[28:31], v[56:59], v[80:83]
    v_mfma_f32_16x16x32_bf16 v[84:87], v[28:31], v[60:63], v[84:87]
    ds_read_b128 v[28:31], v9 offset:21504
    s_waitcnt lgkmcnt(5)
    v_mfma_f32_16x16x32_bf16 v[88:91], v[32:35], v[56:59], v[88:91]
    v_mfma_f32_16x16x32_bf16 v[92:95], v[32:35], v[60:63], v[92:95]
    ds_read_b128 v[32:35], v9 offset:22528
    s_waitcnt lgkmcnt(5)
    v_mfma_f32_16x16x32_bf16 v[96:99], v[36:39], v[56:59], v[96:99]
    v_mfma_f32_16x16x32_bf16 v[100:103], v[36:39], v[60:63], v[100:103]
    ds_read_b128 v[36:39], v9 offset:23552
    s_waitcnt lgkmcnt(5)
    v_mfma_f32_16x16x32_bf16 v[104:107], v[16:19], v[56:59], v[104:107]
    v_mfma_f32_16x16x32_bf16 v[108:111], v[16:19], v[60:63], v[108:111]
    ds_read_b128 v[16:19], v9 offset:24576
    s_waitcnt lgkmcnt(5)
    v_mfma_f32_16x16x32_bf16 v[112:115], v[20:23], v[56:59], v[112:115]
    v_mfma_f32_16x16x32_bf16 v[116:119], v[20:23], v[60:63], v[116:119]
    ds_read_b128 v[20:23], v9 offset:25600
    s_waitcnt lgkmcnt(5)
    v_mfma_f32_16x16x32_bf16 v[120:123], v[24:27], v[56:59], v[120:123]
    v_mfma_f32_16x16x32_bf16 v[124:127], v[24:27], v[60:63], v[124:127]
    ds_read_b128 v[24:27], v9 offset:26624
    buffer_load_dwordx4 v[56:59], v8, s[28:31], s44 offen
    buffer_load_dwordx4 v[60:63], v8, s[28:31], s44 offen offset:256
    v_add_u32 v8, 2048, v8
    s_waitcnt vmcnt(10)
    s_barrier
    s_add_u32 m0, s42, 14336
    s_nop 0
    buffer_load_dwordx4 v7, s[28:31], s40 offen lds
    s_add_u32 m0, s43, 14336
    s_nop 0
    buffer_load_dwordx4 v7, s[28:31], s41 offen lds
    v_add_u32 v7, 2048, v7
    s_waitcnt lgkmcnt(5)
    v_mfma_f32_16x16x32_bf16 v[72:75], v[28:31], v[64:67], v[72:75]
    v_mfma_f32_16x16x32_bf16 v[76:79], v[28:31], v[68:71], v[76:79]
    ds_read_b128 v[28:31], v9 offset:27648
    s_waitcnt lgkmcnt(5)
    v_mfma_f32_16x16x32_bf16 v[80:83], v[32:35], v[64:67], v[80:83]
    v_mfma_f32_16x16x32_bf16 v[84:87], v[32:35], v[68:71], v[84:87]
    ds_read_b128 v[32:35], v9 offset:28672
    s_waitcnt lgkmcnt(5)
    v_mfma_f32_16x16x32_bf16 v[88:91], v[36:39], v[64:67], v[88:91]
    v_mfma_f32_16x16x32_bf16 v[92:95], v[36:39], v[68:71], v[92:95]
    ds_read_b128 v[36:39], v9 offset:29696
    s_waitcnt lgkmcnt(5)
    v_mfma_f32_16x16x32_bf16 v[96:99], v[16:19], v[64:67], v[96:99]
    v_mfma_f32_16x16x32_bf16 v[100:103], v[16:19], v[68:71], v[100:103]
    ds_read_b128 v[16:19], v9 offset:30720
    s_waitcnt lgkmcnt(5)
    v_mfma_f32_16x16x32_bf16 v[104:107], v[20:23], v[64:67], v[104:107]
    v_mfma_f32_16x16x32_bf16 v[108:111], v[20:23], v[68:71], v[108:111]
    ds_read_b128 v[20:23], v9 offset:31744
    s_waitcnt lgkmcnt(5)
    v_mfma_f32_16x16x32_bf16 v[112:115], v[24:27], v[64:67], v[112:115]
    v_mfma_f32_16x16x32_bf16 v[116:119], v[24:27], v[68:71], v[116:119]
    ds_read_b128 v[24:27], v9 offset:32768
    s_waitcnt lgkmcnt(5)
    v_mfma_f32_16x16x32_bf16 v[120:123], v[28:31], v[64:67], v[120:123]
    v_mfma_f32_16x16x32_bf16 v[124:127], v[28:31], v[68:71], v[124:127]
    ds_read_b128 v[28:31], v9 offset:33792
    buffer_load_dwordx4 v[64:67], v8, s[28:31], s44 offen
    buffer_load_dwordx4 v[68:71], v8, s[28:31], s44 offen offset:256
    v_add_u32 v8, 2048, v8
    s_waitcnt vmcnt(10)
    s_barrier
    s_add_u32 m0, s42, 21504
    s_nop 0
    buffer_load_dwordx4 v7, s[28:31], s40 offen lds
    s_add_u32 m0, s43, 21504
    s_nop 0
    buffer_load_dwordx4 v7, s[28:31], s41 offen lds
    v_add_u32 v7, 2048, v7
    s_waitcnt lgkmcnt(5)
    v_mfma_f32_16x16x32_bf16 v[72:75], v[32:35], v[40:43], v[72:75]
    v_mfma_f32_16x16x32_bf16 v[76:79], v[32:35], v[44:47], v[76:79]
    ds_read_b128 v[32:35], v9 offset:34816
    s_waitcnt lgkmcnt(5)
    v_mfma_f32_16x16x32_bf16 v[80:83], v[36:39], v[40:43], v[80:83]
    v_mfma_f32_16x16x32_bf16 v[84:87], v[36:39], v[44:47], v[84:87]
    ds_read_b128 v[36:39], v9 offset:0
    s_waitcnt lgkmcnt(5)
    v_mfma_f32_16x16x32_bf16 v[88:91], v[16:19], v[40:43], v[88:91]
    v_mfma_f32_16x16x32_bf16 v[92:95], v[16:19], v[44:47], v[92:95]
    ds_read_b128 v[16:19], v9 offset:1024
    s_waitcnt lgkmcnt(5)
    v_mfma_f32_16x16x32_bf16 v[96:99], v[20:23], v[40:43], v[96:99]
    v_mfma_f32_16x16x32_bf16 v[100:103], v[20:23], v[44:47], v[100:103]
    ds_read_b128 v[20:23], v9 offset:2048
    s_waitcnt lgkmcnt(5)
    v_mfma_f32_16x16x32_bf16 v[104:107], v[24:27], v[40:43], v[104:107]
    v_mfma_f32_16x16x32_bf16 v[108:111], v[24:27], v[44:47], v[108:111]
    ds_read_b128 v[24:27], v9 offset:3072
    s_waitcnt lgkmcnt(5)
    v_mfma_f32_16x16x32_bf16 v[112:115], v[28:31], v[40:43], v[112:115]
    v_mfma_f32_16x16x32_bf16 v[116:119], v[28:31], v[44:47], v[116:119]
    ds_read_b128 v[28:31], v9 offset:4096
    s_waitcnt lgkmcnt(5)
    v_mfma_f32_16x16x32_bf16 v[120:123], v[32:35], v[40:43], v[120:123]
    v_mfma_f32_16x16x32_bf16 v[124:127], v[32:35], v[44:47], v[124:127]
    ds_read_b128 v[32:35], v9 offset:5120
    buffer_load_dwordx4 v[40:43], v8, s[28:31], s44 offen
    buffer_load_dwordx4 v[44:47], v8, s[28:31], s44 offen offset:256
    v_add_u32 v8, 2048, v8
    s_waitcnt vmcnt(10)
    s_barrier
    s_add_u32 m0, s42, 28672
    s_nop 0
    buffer_load_dwordx4 v7, s[28:31], s40 offen lds
    s_add_u32 m0, s43, 28672
    s_nop 0
    buffer_load_dwordx4 v7, s[28:31], s41 offen lds
    v_add_u32 v7, 2048, v7
    s_waitcnt lgkmcnt(5)
    v_mfma_f32_16x16x32_bf16 v[72:75], v[36:39], v[48:51], v[72:75]
    v_mfma_f32_16x16x32_bf16 v[76:79], v[36:39], v[52:55], v[76:79]
    ds_read_b128 v[36:39], v9 offset:6144
    s_waitcnt lgkmcnt(5)
    v_mfma_f32_16x16x32_bf16 v[80:83], v[16:19], v[48:51], v[80:83]
    v_mfma_f32_16x16x32_bf16 v[84:87], v[16:19], v[52:55], v[84:87]
    ds_read_b128 v[16:19], v9 offset:7168
    s_waitcnt lgkmcnt(5)
    v_mfma_f32_16x16x32_bf16 v[88:91], v[20:23], v[48:51], v[88:91]
    v_mfma_f32_16x16x32_bf16 v[92:95], v[20:23], v[52:55], v[92:95]
    ds_read_b128 v[20:23], v9 offset:8192
    s_waitcnt lgkmcnt(5)
    v_mfma_f32_16x16x32_bf16 v[96:99], v[24:27], v[48:51], v[96:99]
    v_mfma_f32_16x16x32_bf16 v[100:103], v[24:27], v[52:55], v[100:103]
    ds_read_b128 v[24:27], v9 offset:9216
    s_waitcnt lgkmcnt(5)
    v_mfma_f32_16x16x32_bf16 v[104:107], v[28:31], v[48:51], v[104:107]
    v_mfma_f32_16x16x32_bf16 v[108:111], v[28:31], v[52:55], v[108:111]
    ds_read_b128 v[28:31], v9 offset:10240
    s_waitcnt lgkmcnt(5)
    v_mfma_f32_16x16x32_bf16 v[112:115], v[32:35], v[48:51], v[112:115]
    v_mfma_f32_16x16x32_bf16 v[116:119], v[32:35], v[52:55], v[116:119]
    ds_read_b128 v[32:35], v9 offset:11264
    s_waitcnt lgkmcnt(5)
    v_mfma_f32_16x16x32_bf16 v[120:123], v[36:39], v[48:51], v[120:123]
    v_mfma_f32_16x16x32_bf16 v[124:127], v[36:39], v[52:55], v[124:127]
    ds_read_b128 v[36:39], v9 offset:12288
    buffer_load_dwordx4 v[48:51], v8, s[28:31], s44 offen
    buffer_load_dwordx4 v[52:55], v8, s[28:31], s44 offen offset:256
    v_add_u32 v8, 2048, v8
    s_waitcnt vmcnt(10)
    s_barrier
    s_add_u32 m0, s42, 0
    s_nop 0
    buffer_load_dwordx4 v7, s[28:31], s40 offen lds
    s_add_u32 m0, s43, 0
    s_nop 0
    buffer_load_dwordx4 v7, s[28:31], s41 offen lds
    v_add_u32 v7, 2048, v7
    s_waitcnt lgkmcnt(5)
    v_mfma_f32_16x16x32_bf16 v[72:75], v[16:19], v[56:59], v[72:75]
    v_mfma_f32_16x16x32_bf16 v[76:79], v[16:19], v[60:63], v[76:79]
    ds_read_b128 v[16:19], v9 offset:13312
    s_waitcnt lgkmcnt(5)
    v_mfma_f32_16x16x32_bf16 v[80:83], v[20:23], v[56:59], v[80:83]
    v_mfma_f32_16x16x32_bf16 v[84:87], v[20:23], v[60:63], v[84:87]
    ds_read_b128 v[20:23], v9 offset:14336
    s_waitcnt lgkmcnt(5)
    v_mfma_f32_16x16x32_bf16 v[88:91], v[24:27], v[56:59], v[88:91]
    v_mfma_f32_16x16x32_bf16 v[92:95], v[24:27], v[60:63], v[92:95]
    ds_read_b128 v[24:27], v9 offset:15360
    s_waitcnt lgkmcnt(5)
    v_mfma_f32_16x16x32_bf16 v[96:99], v[28:31], v[56:59], v[96:99]
    v_mfma_f32_16x16x32_bf16 v[100:103], v[28:31], v[60:63], v[100:103]
    ds_read_b128 v[28:31], v9 offset:16384
    s_waitcnt lgkmcnt(5)
    v_mfma_f32_16x16x32_bf16 v[104:107], v[32:35], v[56:59], v[104:107]
    v_mfma_f32_16x16x32_bf16 v[108:111], v[32:35], v[60:63], v[108:111]
    ds_read_b128 v[32:35], v9 offset:17408
    s_waitcnt lgkmcnt(5)
    v_mfma_f32_16x16x32_bf16 v[112:115], v[36:39], v[56:59], v[112:115]
    v_mfma_f32_16x16x32_bf16 v[116:119], v[36:39], v[60:63], v[116:119]
    ds_read_b128 v[36:39], v9 offset:18432
    s_waitcnt lgkmcnt(5)
    v_mfma_f32_16x16x32_bf16 v[120:123], v[16:19], v[56:59], v[120:123]
    v_mfma_f32_16x16x32_bf16 v[124:127], v[16:19], v[60:63], v[124:127]
    ds_read_b128 v[16:19], v9 offset:19456
    buffer_load_dwordx4 v[56:59], v8, s[28:31], s44 offen
    buffer_load_dwordx4 v[60:63], v8, s[28:31], s44 offen offset:256
    v_add_u32 v8, 2048, v8
    s_waitcnt vmcnt(10)
    s_barrier
    s_add_u32 m0, s42, 7168
    s_nop 0
    buffer_load_dwordx4 v7, s[28:31], s40 offen lds
    s_add_u32 m0, s43, 7168
    s_nop 0
    buffer_load_dwordx4 v7, s[28:31], s41 offen lds
    v_add_u32 v7, 2048, v7
    s_waitcnt lgkmcnt(5)
    v_mfma_f32_16x16x32_bf16 v[72:75], v[20:23], v[64:67], v[72:75]
    v_mfma_f32_16x16x32_bf16 v[76:79], v[20:23], v[68:71], v[76:79]
    ds_read_b128 v[20:23], v9 offset:20480
    s_waitcnt lgkmcnt(5)
    v_mfma_f32_16x16x32_bf16 v[80:83], v[24:27], v[64:67], v[80:83]
    v_mfma_f32_16x16x32_bf16 v[84:87], v[24:27], v[68:71], v[84:87]
    ds_read_b128 v[24:27], v9 offset:21504
    s_waitcnt lgkmcnt(5)
    v_mfma_f32_16x16x32_bf16 v[88:91], v[28:31], v[64:67], v[88:91]
    v_mfma_f32_16x16x32_bf16 v[92:95], v[28:31], v[68:71], v[92:95]
    ds_read_b128 v[28:31], v9 offset:22528
    s_waitcnt lgkmcnt(5)
    v_mfma_f32_16x16x32_bf16 v[96:99], v[32:35], v[64:67], v[96:99]
    v_mfma_f32_16x16x32_bf16 v[100:103], v[32:35], v[68:71], v[100:103]
    ds_read_b128 v[32:35], v9 offset:23552
    s_waitcnt lgkmcnt(5)
    v_mfma_f32_16x16x32_bf16 v[104:107], v[36:39], v[64:67], v[104:107]
    v_mfma_f32_16x16x32_bf16 v[108:111], v[36:39], v[68:71], v[108:111]
    ds_read_b128 v[36:39], v9 offset:24576
    s_waitcnt lgkmcnt(5)
    v_mfma_f32_16x16x32_bf16 v[112:115], v[16:19], v[64:67], v[112:115]
    v_mfma_f32_16x16x32_bf16 v[116:119], v[16:19], v[68:71], v[116:119]
    ds_read_b128 v[16:19], v9 offset:25600
    s_waitcnt lgkmcnt(5)
    v_mfma_f32_16x16x32_bf16 v[120:123], v[20:23], v[64:67], v[120:123]
    v_mfma_f32_16x16x32_bf16 v[124:127], v[20:23], v[68:71], v[124:127]
    ds_read_b128 v[20:23], v9 offset:26624
    buffer_load_dwordx4 v[64:67], v8, s[28:31], s44 offen
    buffer_load_dwordx4 v[68:71], v8, s[28:31], s44 offen offset:256
    v_add_u32 v8, 2048, v8
    s_waitcnt vmcnt(10)
    s_barrier
    s_add_u32 m0, s42, 14336
    s_nop 0
    buffer_load_dwordx4 v7, s[28:31], s40 offen lds
    s_add_u32 m0, s43, 14336
    s_nop 0
    buffer_load_dwordx4 v7, s[28:31], s41 offen lds
    v_add_u32 v7, 2048, v7
    s_waitcnt lgkmcnt(5)
    v_mfma_f32_16x16x32_bf16 v[72:75], v[24:27], v[40:43], v[72:75]
    v_mfma_f32_16x16x32_bf16 v[76:79], v[24:27], v[44:47], v[76:79]
    ds_read_b128 v[24:27], v9 offset:27648
    s_waitcnt lgkmcnt(5)
    v_mfma_f32_16x16x32_bf16 v[80:83], v[28:31], v[40:43], v[80:83]
    v_mfma_f32_16x16x32_bf16 v[84:87], v[28:31], v[44:47], v[84:87]
    ds_read_b128 v[28:31], v9 offset:28672
    s_waitcnt lgkmcnt(5)
    v_mfma_f32_16x16x32_bf16 v[88:91], v[32:35], v[40:43], v[88:91]
    v_mfma_f32_16x16x32_bf16 v[92:95], v[32:35], v[44:47], v[92:95]
    ds_read_b128 v[32:35], v9 offset:29696
    s_waitcnt lgkmcnt(5)
    v_mfma_f32_16x16x32_bf16 v[96:99], v[36:39], v[40:43], v[96:99]
    v_mfma_f32_16x16x32_bf16 v[100:103], v[36:39], v[44:47], v[100:103]
    ds_read_b128 v[36:39], v9 offset:30720
    s_waitcnt lgkmcnt(5)
    v_mfma_f32_16x16x32_bf16 v[104:107], v[16:19], v[40:43], v[104:107]
    v_mfma_f32_16x16x32_bf16 v[108:111], v[16:19], v[44:47], v[108:111]
    ds_read_b128 v[16:19], v9 offset:31744
    s_waitcnt lgkmcnt(5)
    v_mfma_f32_16x16x32_bf16 v[112:115], v[20:23], v[40:43], v[112:115]
    v_mfma_f32_16x16x32_bf16 v[116:119], v[20:23], v[44:47], v[116:119]
    ds_read_b128 v[20:23], v9 offset:32768
    s_waitcnt lgkmcnt(5)
    v_mfma_f32_16x16x32_bf16 v[120:123], v[24:27], v[40:43], v[120:123]
    v_mfma_f32_16x16x32_bf16 v[124:127], v[24:27], v[44:47], v[124:127]
    ds_read_b128 v[24:27], v9 offset:33792
    buffer_load_dwordx4 v[40:43], v8, s[28:31], s44 offen
    buffer_load_dwordx4 v[44:47], v8, s[28:31], s44 offen offset:256
    v_add_u32 v8, 2048, v8
    s_waitcnt vmcnt(10)
    s_barrier
    s_add_u32 m0, s42, 21504
    s_nop 0
    buffer_load_dwordx4 v7, s[28:31], s40 offen lds
    s_add_u32 m0, s43, 21504
    s_nop 0
    buffer_load_dwordx4 v7, s[28:31], s41 offen lds
    v_add_u32 v7, 2048, v7
    s_waitcnt lgkmcnt(5)
    v_mfma_f32_16x16x32_bf16 v[72:75], v[28:31], v[48:51], v[72:75]
    v_mfma_f32_16x16x32_bf16 v[76:79], v[28:31], v[52:55], v[76:79]
    ds_read_b128 v[28:31], v9 offset:34816
    s_waitcnt lgkmcnt(5)
    v_mfma_f32_16x16x32_bf16 v[80:83], v[32:35], v[48:51], v[80:83]
    v_mfma_f32_16x16x32_bf16 v[84:87], v[32:35], v[52:55], v[84:87]
    ds_read_b128 v[32:35], v9 offset:0
    s_waitcnt lgkmcnt(5)
    v_mfma_f32_16x16x32_bf16 v[88:91], v[36:39], v[48:51], v[88:91]
    v_mfma_f32_16x16x32_bf16 v[92:95], v[36:39], v[52:55], v[92:95]
    ds_read_b128 v[36:39], v9 offset:1024
    s_waitcnt lgkmcnt(5)
    v_mfma_f32_16x16x32_bf16 v[96:99], v[16:19], v[48:51], v[96:99]
    v_mfma_f32_16x16x32_bf16 v[100:103], v[16:19], v[52:55], v[100:103]
    ds_read_b128 v[16:19], v9 offset:2048
    s_waitcnt lgkmcnt(5)
    v_mfma_f32_16x16x32_bf16 v[104:107], v[20:23], v[48:51], v[104:107]
    v_mfma_f32_16x16x32_bf16 v[108:111], v[20:23], v[52:55], v[108:111]
    ds_read_b128 v[20:23], v9 offset:3072
    s_waitcnt lgkmcnt(5)
    v_mfma_f32_16x16x32_bf16 v[112:115], v[24:27], v[48:51], v[112:115]
    v_mfma_f32_16x16x32_bf16 v[116:119], v[24:27], v[52:55], v[116:119]
    ds_read_b128 v[24:27], v9 offset:4096
    s_waitcnt lgkmcnt(5)
    v_mfma_f32_16x16x32_bf16 v[120:123], v[28:31], v[48:51], v[120:123]
    v_mfma_f32_16x16x32_bf16 v[124:127], v[28:31], v[52:55], v[124:127]
    ds_read_b128 v[28:31], v9 offset:5120
    buffer_load_dwordx4 v[48:51], v8, s[28:31], s44 offen
    buffer_load_dwordx4 v[52:55], v8, s[28:31], s44 offen offset:256
    v_add_u32 v8, 2048, v8
    s_waitcnt vmcnt(10)
    s_barrier
    s_add_u32 m0, s42, 28672
    s_nop 0
    buffer_load_dwordx4 v7, s[28:31], s40 offen lds
    s_add_u32 m0, s43, 28672
    s_nop 0
    buffer_load_dwordx4 v7, s[28:31], s41 offen lds
    v_add_u32 v7, 2048, v7
    s_waitcnt lgkmcnt(5)
    v_mfma_f32_16x16x32_bf16 v[72:75], v[32:35], v[56:59], v[72:75]
    v_mfma_f32_16x16x32_bf16 v[76:79], v[32:35], v[60:63], v[76:79]
    ds_read_b128 v[32:35], v9 offset:6144
    s_waitcnt lgkmcnt(5)
    v_mfma_f32_16x16x32_bf16 v[80:83], v[36:39], v[56:59], v[80:83]
    v_mfma_f32_16x16x32_bf16 v[84:87], v[36:39], v[60:63], v[84:87]
    ds_read_b128 v[36:39], v9 offset:7168
    s_waitcnt lgkmcnt(5)
    v_mfma_f32_16x16x32_bf16 v[88:91], v[16:19], v[56:59], v[88:91]
    v_mfma_f32_16x16x32_bf16 v[92:95], v[16:19], v[60:63], v[92:95]
    ds_read_b128 v[16:19], v9 offset:8192
    s_waitcnt lgkmcnt(5)
    v_mfma_f32_16x16x32_bf16 v[96:99], v[20:23], v[56:59], v[96:99]
    v_mfma_f32_16x16x32_bf16 v[100:103], v[20:23], v[60:63], v[100:103]
    ds_read_b128 v[20:23], v9 offset:9216
    s_waitcnt lgkmcnt(5)
    v_mfma_f32_16x16x32_bf16 v[104:107], v[24:27], v[56:59], v[104:107]
    v_mfma_f32_16x16x32_bf16 v[108:111], v[24:27], v[60:63], v[108:111]
    ds_read_b128 v[24:27], v9 offset:10240
    s_waitcnt lgkmcnt(5)
    v_mfma_f32_16x16x32_bf16 v[112:115], v[28:31], v[56:59], v[112:115]
    v_mfma_f32_16x16x32_bf16 v[116:119], v[28:31], v[60:63], v[116:119]
    ds_read_b128 v[28:31], v9 offset:11264
    s_waitcnt lgkmcnt(5)
    v_mfma_f32_16x16x32_bf16 v[120:123], v[32:35], v[56:59], v[120:123]
    v_mfma_f32_16x16x32_bf16 v[124:127], v[32:35], v[60:63], v[124:127]
    ds_read_b128 v[32:35], v9 offset:12288
    buffer_load_dwordx4 v[56:59], v8, s[28:31], s44 offen
    buffer_load_dwordx4 v[60:63], v8, s[28:31], s44 offen offset:256
    v_add_u32 v8, 2048, v8
    s_waitcnt vmcnt(10)
    s_barrier
    s_add_u32 m0, s42, 0
    s_nop 0
    buffer_load_dwordx4 v7, s[28:31], s40 offen lds
    s_add_u32 m0, s43, 0
    s_nop 0
    buffer_load_dwordx4 v7, s[28:31], s41 offen lds
    v_add_u32 v7, 2048, v7
    s_waitcnt lgkmcnt(5)
    v_mfma_f32_16x16x32_bf16 v[72:75], v[36:39], v[64:67], v[72:75]
    v_mfma_f32_16x16x32_bf16 v[76:79], v[36:39], v[68:71], v[76:79]
    ds_read_b128 v[36:39], v9 offset:13312
    s_waitcnt lgkmcnt(5)
    v_mfma_f32_16x16x32_bf16 v[80:83], v[16:19], v[64:67], v[80:83]
    v_mfma_f32_16x16x32_bf16 v[84:87], v[16:19], v[68:71], v[84:87]
    ds_read_b128 v[16:19], v9 offset:14336
    s_waitcnt lgkmcnt(5)
    v_mfma_f32_16x16x32_bf16 v[88:91], v[20:23], v[64:67], v[88:91]
    v_mfma_f32_16x16x32_bf16 v[92:95], v[20:23], v[68:71], v[92:95]
    ds_read_b128 v[20:23], v9 offset:15360
    s_waitcnt lgkmcnt(5)
    v_mfma_f32_16x16x32_bf16 v[96:99], v[24:27], v[64:67], v[96:99]
    v_mfma_f32_16x16x32_bf16 v[100:103], v[24:27], v[68:71], v[100:103]
    ds_read_b128 v[24:27], v9 offset:16384
    s_waitcnt lgkmcnt(5)
    v_mfma_f32_16x16x32_bf16 v[104:107], v[28:31], v[64:67], v[104:107]
    v_mfma_f32_16x16x32_bf16 v[108:111], v[28:31], v[68:71], v[108:111]
    ds_read_b128 v[28:31], v9 offset:17408
    s_waitcnt lgkmcnt(5)
    v_mfma_f32_16x16x32_bf16 v[112:115], v[32:35], v[64:67], v[112:115]
    v_mfma_f32_16x16x32_bf16 v[116:119], v[32:35], v[68:71], v[116:119]
    ds_read_b128 v[32:35], v9 offset:18432
    s_waitcnt lgkmcnt(5)
    v_mfma_f32_16x16x32_bf16 v[120:123], v[36:39], v[64:67], v[120:123]
    v_mfma_f32_16x16x32_bf16 v[124:127], v[36:39], v[68:71], v[124:127]
    ds_read_b128 v[36:39], v9 offset:19456
    buffer_load_dwordx4 v[64:67], v8, s[28:31], s44 offen
    buffer_load_dwordx4 v[68:71], v8, s[28:31], s44 offen offset:256
    v_add_u32 v8, 2048, v8
    s_waitcnt vmcnt(10)
    s_barrier
    s_add_u32 m0, s42, 7168
    s_nop 0
    buffer_load_dwordx4 v7, s[28:31], s40 offen lds
    s_add_u32 m0, s43, 7168
    s_nop 0
    buffer_load_dwordx4 v7, s[28:31], s41 offen lds
    v_add_u32 v7, 2048, v7
    s_waitcnt lgkmcnt(5)
    v_mfma_f32_16x16x32_bf16 v[72:75], v[16:19], v[40:43], v[72:75]
    v_mfma_f32_16x16x32_bf16 v[76:79], v[16:19], v[44:47], v[76:79]
    ds_read_b128 v[16:19], v9 offset:20480
    s_waitcnt lgkmcnt(5)
    v_mfma_f32_16x16x32_bf16 v[80:83], v[20:23], v[40:43], v[80:83]
    v_mfma_f32_16x16x32_bf16 v[84:87], v[20:23], v[44:47], v[84:87]
    ds_read_b128 v[20:23], v9 offset:21504
    s_waitcnt lgkmcnt(5)
    v_mfma_f32_16x16x32_bf16 v[88:91], v[24:27], v[40:43], v[88:91]
    v_mfma_f32_16x16x32_bf16 v[92:95], v[24:27], v[44:47], v[92:95]
    ds_read_b128 v[24:27], v9 offset:22528
    s_waitcnt lgkmcnt(5)
    v_mfma_f32_16x16x32_bf16 v[96:99], v[28:31], v[40:43], v[96:99]
    v_mfma_f32_16x16x32_bf16 v[100:103], v[28:31], v[44:47], v[100:103]
    ds_read_b128 v[28:31], v9 offset:23552
    s_waitcnt lgkmcnt(5)
    v_mfma_f32_16x16x32_bf16 v[104:107], v[32:35], v[40:43], v[104:107]
    v_mfma_f32_16x16x32_bf16 v[108:111], v[32:35], v[44:47], v[108:111]
    ds_read_b128 v[32:35], v9 offset:24576
    s_waitcnt lgkmcnt(5)
    v_mfma_f32_16x16x32_bf16 v[112:115], v[36:39], v[40:43], v[112:115]
    v_mfma_f32_16x16x32_bf16 v[116:119], v[36:39], v[44:47], v[116:119]
    ds_read_b128 v[36:39], v9 offset:25600
    s_waitcnt lgkmcnt(5)
    v_mfma_f32_16x16x32_bf16 v[120:123], v[16:19], v[40:43], v[120:123]
    v_mfma_f32_16x16x32_bf16 v[124:127], v[16:19], v[44:47], v[124:127]
    ds_read_b128 v[16:19], v9 offset:26624
    buffer_load_dwordx4 v[40:43], v8, s[28:31], s44 offen
    buffer_load_dwordx4 v[44:47], v8, s[28:31], s44 offen offset:256
    v_add_u32 v8, 2048, v8
    s_waitcnt vmcnt(10)
    s_barrier
    s_add_u32 m0, s42, 14336
    s_nop 0
    buffer_load_dwordx4 v7, s[28:31], s40 offen lds
    s_add_u32 m0, s43, 14336
    s_nop 0
    buffer_load_dwordx4 v7, s[28:31], s41 offen lds
    v_add_u32 v7, 2048, v7
    s_waitcnt lgkmcnt(5)
    v_mfma_f32_16x16x32_bf16 v[72:75], v[20:23], v[48:51], v[72:75]
    v_mfma_f32_16x16x32_bf16 v[76:79], v[20:23], v[52:55], v[76:79]
    ds_read_b128 v[20:23], v9 offset:27648
    s_waitcnt lgkmcnt(5)
    v_mfma_f32_16x16x32_bf16 v[80:83], v[24:27], v[48:51], v[80:83]
    v_mfma_f32_16x16x32_bf16 v[84:87], v[24:27], v[52:55], v[84:87]
    ds_read_b128 v[24:27], v9 offset:28672
    s_waitcnt lgkmcnt(5)
    v_mfma_f32_16x16x32_bf16 v[88:91], v[28:31], v[48:51], v[88:91]
    v_mfma_f32_16x16x32_bf16 v[92:95], v[28:31], v[52:55], v[92:95]
    ds_read_b128 v[28:31], v9 offset:29696
    s_waitcnt lgkmcnt(5)
    v_mfma_f32_16x16x32_bf16 v[96:99], v[32:35], v[48:51], v[96:99]
    v_mfma_f32_16x16x32_bf16 v[100:103], v[32:35], v[52:55], v[100:103]
    ds_read_b128 v[32:35], v9 offset:30720
    s_waitcnt lgkmcnt(5)
    v_mfma_f32_16x16x32_bf16 v[104:107], v[36:39], v[48:51], v[104:107]
    v_mfma_f32_16x16x32_bf16 v[108:111], v[36:39], v[52:55], v[108:111]
    ds_read_b128 v[36:39], v9 offset:31744
    s_waitcnt lgkmcnt(5)
    v_mfma_f32_16x16x32_bf16 v[112:115], v[16:19], v[48:51], v[112:115]
    v_mfma_f32_16x16x32_bf16 v[116:119], v[16:19], v[52:55], v[116:119]
    ds_read_b128 v[16:19], v9 offset:32768
    s_waitcnt lgkmcnt(5)
    v_mfma_f32_16x16x32_bf16 v[120:123], v[20:23], v[48:51], v[120:123]
    v_mfma_f32_16x16x32_bf16 v[124:127], v[20:23], v[52:55], v[124:127]
    ds_read_b128 v[20:23], v9 offset:33792
    buffer_load_dwordx4 v[48:51], v8, s[28:31], s44 offen
    buffer_load_dwordx4 v[52:55], v8, s[28:31], s44 offen offset:256
    v_add_u32 v8, 2048, v8
    s_waitcnt vmcnt(10)
    s_barrier
    s_add_u32 m0, s42, 21504
    s_nop 0
    buffer_load_dwordx4 v7, s[28:31], s40 offen lds
    s_add_u32 m0, s43, 21504
    s_nop 0
    buffer_load_dwordx4 v7, s[28:31], s41 offen lds
    v_add_u32 v7, 2048, v7
    s_waitcnt lgkmcnt(5)
    v_mfma_f32_16x16x32_bf16 v[72:75], v[24:27], v[56:59], v[72:75]
    v_mfma_f32_16x16x32_bf16 v[76:79], v[24:27], v[60:63], v[76:79]
    ds_read_b128 v[24:27], v9 offset:34816
    s_waitcnt lgkmcnt(5)
    v_mfma_f32_16x16x32_bf16 v[80:83], v[28:31], v[56:59], v[80:83]
    v_mfma_f32_16x16x32_bf16 v[84:87], v[28:31], v[60:63], v[84:87]
    ds_read_b128 v[28:31], v9 offset:0
    s_waitcnt lgkmcnt(5)
    v_mfma_f32_16x16x32_bf16 v[88:91], v[32:35], v[56:59], v[88:91]
    v_mfma_f32_16x16x32_bf16 v[92:95], v[32:35], v[60:63], v[92:95]
    ds_read_b128 v[32:35], v9 offset:1024
    s_waitcnt lgkmcnt(5)
    v_mfma_f32_16x16x32_bf16 v[96:99], v[36:39], v[56:59], v[96:99]
    v_mfma_f32_16x16x32_bf16 v[100:103], v[36:39], v[60:63], v[100:103]
    ds_read_b128 v[36:39], v9 offset:2048
    s_waitcnt lgkmcnt(5)
    v_mfma_f32_16x16x32_bf16 v[104:107], v[16:19], v[56:59], v[104:107]
    v_mfma_f32_16x16x32_bf16 v[108:111], v[16:19], v[60:63], v[108:111]
    ds_read_b128 v[16:19], v9 offset:3072
    s_waitcnt lgkmcnt(5)
    v_mfma_f32_16x16x32_bf16 v[112:115], v[20:23], v[56:59], v[112:115]
    v_mfma_f32_16x16x32_bf16 v[116:119], v[20:23], v[60:63], v[116:119]
    ds_read_b128 v[20:23], v9 offset:4096
    s_waitcnt lgkmcnt(5)
    v_mfma_f32_16x16x32_bf16 v[120:123], v[24:27], v[56:59], v[120:123]
    v_mfma_f32_16x16x32_bf16 v[124:127], v[24:27], v[60:63], v[124:127]
    ds_read_b128 v[24:27], v9 offset:5120
    buffer_load_dwordx4 v[56:59], v8, s[28:31], s44 offen
    buffer_load_dwordx4 v[60:63], v8, s[28:31], s44 offen offset:256
    v_add_u32 v8, 2048, v8
    s_waitcnt vmcnt(10)
    s_barrier
    s_add_u32 m0, s42, 28672
    s_nop 0
    buffer_load_dwordx4 v7, s[28:31], s40 offen lds
    s_add_u32 m0, s43, 28672
    s_nop 0
    buffer_load_dwordx4 v7, s[28:31], s41 offen lds
    v_add_u32 v7, 2048, v7
    s_waitcnt lgkmcnt(5)
    v_mfma_f32_16x16x32_bf16 v[72:75], v[28:31], v[64:67], v[72:75]
    v_mfma_f32_16x16x32_bf16 v[76:79], v[28:31], v[68:71], v[76:79]
    ds_read_b128 v[28:31], v9 offset:6144
    s_waitcnt lgkmcnt(5)
    v_mfma_f32_16x16x32_bf16 v[80:83], v[32:35], v[64:67], v[80:83]
    v_mfma_f32_16x16x32_bf16 v[84:87], v[32:35], v[68:71], v[84:87]
    ds_read_b128 v[32:35], v9 offset:7168
    s_waitcnt lgkmcnt(5)
    v_mfma_f32_16x16x32_bf16 v[88:91], v[36:39], v[64:67], v[88:91]
    v_mfma_f32_16x16x32_bf16 v[92:95], v[36:39], v[68:71], v[92:95]
    ds_read_b128 v[36:39], v9 offset:8192
    s_waitcnt lgkmcnt(5)
    v_mfma_f32_16x16x32_bf16 v[96:99], v[16:19], v[64:67], v[96:99]
    v_mfma_f32_16x16x32_bf16 v[100:103], v[16:19], v[68:71], v[100:103]
    ds_read_b128 v[16:19], v9 offset:9216
    s_waitcnt lgkmcnt(5)
    v_mfma_f32_16x16x32_bf16 v[104:107], v[20:23], v[64:67], v[104:107]
    v_mfma_f32_16x16x32_bf16 v[108:111], v[20:23], v[68:71], v[108:111]
    ds_read_b128 v[20:23], v9 offset:10240
    s_waitcnt lgkmcnt(5)
    v_mfma_f32_16x16x32_bf16 v[112:115], v[24:27], v[64:67], v[112:115]
    v_mfma_f32_16x16x32_bf16 v[116:119], v[24:27], v[68:71], v[116:119]
    ds_read_b128 v[24:27], v9 offset:11264
    s_waitcnt lgkmcnt(5)
    v_mfma_f32_16x16x32_bf16 v[120:123], v[28:31], v[64:67], v[120:123]
    v_mfma_f32_16x16x32_bf16 v[124:127], v[28:31], v[68:71], v[124:127]
    ds_read_b128 v[28:31], v9 offset:12288
    buffer_load_dwordx4 v[64:67], v8, s[28:31], s44 offen
    buffer_load_dwordx4 v[68:71], v8, s[28:31], s44 offen offset:256
    v_add_u32 v8, 2048, v8
    s_waitcnt vmcnt(10)
    s_barrier
    s_waitcnt lgkmcnt(5)
    v_mfma_f32_16x16x32_bf16 v[72:75], v[32:35], v[40:43], v[72:75]
    v_mfma_f32_16x16x32_bf16 v[76:79], v[32:35], v[44:47], v[76:79]
    ds_read_b128 v[32:35], v9 offset:13312
    s_waitcnt lgkmcnt(5)
    v_mfma_f32_16x16x32_bf16 v[80:83], v[36:39], v[40:43], v[80:83]
    v_mfma_f32_16x16x32_bf16 v[84:87], v[36:39], v[44:47], v[84:87]
    ds_read_b128 v[36:39], v9 offset:14336
    s_waitcnt lgkmcnt(5)
    v_mfma_f32_16x16x32_bf16 v[88:91], v[16:19], v[40:43], v[88:91]
    v_mfma_f32_16x16x32_bf16 v[92:95], v[16:19], v[44:47], v[92:95]
    ds_read_b128 v[16:19], v9 offset:15360
    s_waitcnt lgkmcnt(5)
    v_mfma_f32_16x16x32_bf16 v[96:99], v[20:23], v[40:43], v[96:99]
    v_mfma_f32_16x16x32_bf16 v[100:103], v[20:23], v[44:47], v[100:103]
    ds_read_b128 v[20:23], v9 offset:16384
    s_waitcnt lgkmcnt(5)
    v_mfma_f32_16x16x32_bf16 v[104:107], v[24:27], v[40:43], v[104:107]
    v_mfma_f32_16x16x32_bf16 v[108:111], v[24:27], v[44:47], v[108:111]
    ds_read_b128 v[24:27], v9 offset:17408
    s_waitcnt lgkmcnt(5)
    v_mfma_f32_16x16x32_bf16 v[112:115], v[28:31], v[40:43], v[112:115]
    v_mfma_f32_16x16x32_bf16 v[116:119], v[28:31], v[44:47], v[116:119]
    ds_read_b128 v[28:31], v9 offset:18432
    s_waitcnt lgkmcnt(5)
    v_mfma_f32_16x16x32_bf16 v[120:123], v[32:35], v[40:43], v[120:123]
    v_mfma_f32_16x16x32_bf16 v[124:127], v[32:35], v[44:47], v[124:127]
    ds_read_b128 v[32:35], v9 offset:19456
    s_waitcnt vmcnt(6)
    s_barrier
    s_waitcnt lgkmcnt(5)
    v_mfma_f32_16x16x32_bf16 v[72:75], v[36:39], v[48:51], v[72:75]
    v_mfma_f32_16x16x32_bf16 v[76:79], v[36:39], v[52:55], v[76:79]
    ds_read_b128 v[36:39], v9 offset:20480
    s_waitcnt lgkmcnt(5)
    v_mfma_f32_16x16x32_bf16 v[80:83], v[16:19], v[48:51], v[80:83]
    v_mfma_f32_16x16x32_bf16 v[84:87], v[16:19], v[52:55], v[84:87]
    ds_read_b128 v[16:19], v9 offset:21504
    s_waitcnt lgkmcnt(5)
    v_mfma_f32_16x16x32_bf16 v[88:91], v[20:23], v[48:51], v[88:91]
    v_mfma_f32_16x16x32_bf16 v[92:95], v[20:23], v[52:55], v[92:95]
    ds_read_b128 v[20:23], v9 offset:22528
    s_waitcnt lgkmcnt(5)
    v_mfma_f32_16x16x32_bf16 v[96:99], v[24:27], v[48:51], v[96:99]
    v_mfma_f32_16x16x32_bf16 v[100:103], v[24:27], v[52:55], v[100:103]
    ds_read_b128 v[24:27], v9 offset:23552
    s_waitcnt lgkmcnt(5)
    v_mfma_f32_16x16x32_bf16 v[104:107], v[28:31], v[48:51], v[104:107]
    v_mfma_f32_16x16x32_bf16 v[108:111], v[28:31], v[52:55], v[108:111]
    ds_read_b128 v[28:31], v9 offset:24576
    s_waitcnt lgkmcnt(5)
    v_mfma_f32_16x16x32_bf16 v[112:115], v[32:35], v[48:51], v[112:115]
    v_mfma_f32_16x16x32_bf16 v[116:119], v[32:35], v[52:55], v[116:119]
    ds_read_b128 v[32:35], v9 offset:25600
    s_waitcnt lgkmcnt(5)
    v_mfma_f32_16x16x32_bf16 v[120:123], v[36:39], v[48:51], v[120:123]
    v_mfma_f32_16x16x32_bf16 v[124:127], v[36:39], v[52:55], v[124:127]
    ds_read_b128 v[36:39], v9 offset:26624
    s_waitcnt vmcnt(2)
    s_barrier
    s_waitcnt lgkmcnt(5)
    v_mfma_f32_16x16x32_bf16 v[72:75], v[16:19], v[56:59], v[72:75]
    v_mfma_f32_16x16x32_bf16 v[76:79], v[16:19], v[60:63], v[76:79]
    ds_read_b128 v[16:19], v9 offset:27648
    s_waitcnt lgkmcnt(5)
    v_mfma_f32_16x16x32_bf16 v[80:83], v[20:23], v[56:59], v[80:83]
    v_mfma_f32_16x16x32_bf16 v[84:87], v[20:23], v[60:63], v[84:87]
    ds_read_b128 v[20:23], v9 offset:28672
    s_waitcnt lgkmcnt(5)
    v_mfma_f32_16x16x32_bf16 v[88:91], v[24:27], v[56:59], v[88:91]
    v_mfma_f32_16x16x32_bf16 v[92:95], v[24:27], v[60:63], v[92:95]
    ds_read_b128 v[24:27], v9 offset:29696
    s_waitcnt lgkmcnt(5)
    v_mfma_f32_16x16x32_bf16 v[96:99], v[28:31], v[56:59], v[96:99]
    v_mfma_f32_16x16x32_bf16 v[100:103], v[28:31], v[60:63], v[100:103]
    ds_read_b128 v[28:31], v9 offset:30720
    s_waitcnt lgkmcnt(5)
    v_mfma_f32_16x16x32_bf16 v[104:107], v[32:35], v[56:59], v[104:107]
    v_mfma_f32_16x16x32_bf16 v[108:111], v[32:35], v[60:63], v[108:111]
    ds_read_b128 v[32:35], v9 offset:31744
    s_waitcnt lgkmcnt(5)
    v_mfma_f32_16x16x32_bf16 v[112:115], v[36:39], v[56:59], v[112:115]
    v_mfma_f32_16x16x32_bf16 v[116:119], v[36:39], v[60:63], v[116:119]
    ds_read_b128 v[36:39], v9 offset:32768
    s_waitcnt lgkmcnt(5)
    v_mfma_f32_16x16x32_bf16 v[120:123], v[16:19], v[56:59], v[120:123]
    v_mfma_f32_16x16x32_bf16 v[124:127], v[16:19], v[60:63], v[124:127]
    ds_read_b128 v[16:19], v9 offset:33792
    buffer_load_dwordx2 v[48:49], v10, s[8:11], 0 offen offset:0
    buffer_load_dwordx2 v[50:51], v10, s[8:11], 0 offen offset:32
    buffer_load_dwordx2 v[52:53], v10, s[8:11], 0 offen offset:64
    buffer_load_dwordx2 v[54:55], v10, s[8:11], 0 offen offset:96
    buffer_load_dwordx2 v[56:57], v10, s[8:11], 0 offen offset:128
    buffer_load_dwordx2 v[58:59], v10, s[8:11], 0 offen offset:160
    buffer_load_dwordx2 v[60:61], v10, s[8:11], 0 offen offset:192
    s_waitcnt vmcnt(7)
    s_waitcnt lgkmcnt(5)
    v_mfma_f32_16x16x32_bf16 v[72:75], v[20:23], v[64:67], v[72:75]
    v_mfma_f32_16x16x32_bf16 v[76:79], v[20:23], v[68:71], v[76:79]
    ds_read_b128 v[20:23], v9 offset:34816
    s_waitcnt lgkmcnt(5)
    v_mfma_f32_16x16x32_bf16 v[80:83], v[24:27], v[64:67], v[80:83]
    v_mfma_f32_16x16x32_bf16 v[84:87], v[24:27], v[68:71], v[84:87]
    s_waitcnt lgkmcnt(4)
    v_mfma_f32_16x16x32_bf16 v[88:91], v[28:31], v[64:67], v[88:91]
    v_mfma_f32_16x16x32_bf16 v[92:95], v[28:31], v[68:71], v[92:95]
    s_waitcnt lgkmcnt(3)
    v_mfma_f32_16x16x32_bf16 v[96:99], v[32:35], v[64:67], v[96:99]
    v_mfma_f32_16x16x32_bf16 v[100:103], v[32:35], v[68:71], v[100:103]
    s_waitcnt lgkmcnt(2)
    v_mfma_f32_16x16x32_bf16 v[104:107], v[36:39], v[64:67], v[104:107]
    v_mfma_f32_16x16x32_bf16 v[108:111], v[36:39], v[68:71], v[108:111]
    s_waitcnt lgkmcnt(1)
    v_mfma_f32_16x16x32_bf16 v[112:115], v[16:19], v[64:67], v[112:115]
    v_mfma_f32_16x16x32_bf16 v[116:119], v[16:19], v[68:71], v[116:119]
    s_waitcnt lgkmcnt(0)
    v_mfma_f32_16x16x32_bf16 v[120:123], v[20:23], v[64:67], v[120:123]
    v_mfma_f32_16x16x32_bf16 v[124:127], v[20:23], v[68:71], v[124:127]
    s_nop 7
    s_waitcnt vmcnt(0)
    s_mul_i32 s6, s27, 108
    s_add_u32 s6, s6, s4
    s_lshl_b32 s6, s6, 10
    s_add_u32 s6, s6, 13631488
    v_lshlrev_b32 v9, 4, v3
    v_lshl_add_u32 v9, v5, 9, v9
    v_lshl_add_u32 v9, v6, 3, v9
    s_mov_b32 s46, 0x3fb8aa3b
    s_mov_b32 s47, 0x3fb8aa3b
    v_mov_b32 v40, 1.0
    v_mov_b32 v41, 1.0
    v_mov_b32 v42, -2.0
    v_mov_b32 v43, -2.0
    v_lshlrev_b32 v16, 16, v48
    v_and_b32 v17, 0xffff0000, v48
    v_lshlrev_b32 v18, 16, v49
    v_and_b32 v19, 0xffff0000, v49
    v_cvt_pk_bf16_f32 v28, v72, v73
    v_cvt_pk_bf16_f32 v29, v74, v75
    v_lshlrev_b32 v20, 16, v28
    v_and_b32 v21, 0xffff0000, v28
    v_lshlrev_b32 v24, 16, v29
    v_and_b32 v25, 0xffff0000, v29
    v_pk_add_f32 v[20:21], v[20:21], v[16:17]
    v_pk_add_f32 v[24:25], v[24:25], v[18:19]
    v_cvt_pk_bf16_f32 v28, v20, v21
    v_cvt_pk_bf16_f32 v29, v24, v25
    v_lshlrev_b32 v20, 16, v28
    v_and_b32 v21, 0xffff0000, v28
    v_lshlrev_b32 v24, 16, v29
    v_and_b32 v25, 0xffff0000, v29
    v_pk_mul_f32 v[22:23], v[20:21], s[46:47]
    v_pk_mul_f32 v[26:27], v[24:25], s[46:47]
    v_exp_f32 v22, v22
    v_exp_f32 v23, v23
    v_exp_f32 v26, v26
    v_exp_f32 v27, v27
    v_pk_add_f32 v[22:23], v[22:23], v[40:41]
    v_pk_add_f32 v[26:27], v[26:27], v[40:41]
    v_pk_fma_f32 v[22:23], v[22:23], v[22:23], v[40:41]
    v_pk_fma_f32 v[26:27], v[26:27], v[26:27], v[40:41]
    v_rcp_f32 v22, v22
    v_rcp_f32 v23, v23
    v_rcp_f32 v26, v26
    v_rcp_f32 v27, v27
    v_pk_fma_f32 v[22:23], v[22:23], v[42:43], v[40:41]
    v_pk_fma_f32 v[26:27], v[26:27], v[42:43], v[40:41]
    v_pk_mul_f32 v[20:21], v[20:21], v[22:23]
    v_pk_mul_f32 v[24:25], v[24:25], v[26:27]
    v_cvt_pk_bf16_f32 v32, v20, v21
    v_cvt_pk_bf16_f32 v33, v24, v25
    buffer_store_dwordx2 v[32:33], v9, s[28:31], s6 offen offset:0 sc1
    v_cvt_pk_bf16_f32 v28, v76, v77
    v_cvt_pk_bf16_f32 v29, v78, v79
    v_lshlrev_b32 v20, 16, v28
    v_and_b32 v21, 0xffff0000, v28
    v_lshlrev_b32 v24, 16, v29
    v_and_b32 v25, 0xffff0000, v29
    v_pk_add_f32 v[20:21], v[20:21], v[16:17]
    v_pk_add_f32 v[24:25], v[24:25], v[18:19]
    v_cvt_pk_bf16_f32 v28, v20, v21
    v_cvt_pk_bf16_f32 v29, v24, v25
    v_lshlrev_b32 v20, 16, v28
    v_and_b32 v21, 0xffff0000, v28
    v_lshlrev_b32 v24, 16, v29
    v_and_b32 v25, 0xffff0000, v29
    v_pk_mul_f32 v[22:23], v[20:21], s[46:47]
    v_pk_mul_f32 v[26:27], v[24:25], s[46:47]
    v_exp_f32 v22, v22
    v_exp_f32 v23, v23
    v_exp_f32 v26, v26
    v_exp_f32 v27, v27
    v_pk_add_f32 v[22:23], v[22:23], v[40:41]
    v_pk_add_f32 v[26:27], v[26:27], v[40:41]
    v_pk_fma_f32 v[22:23], v[22:23], v[22:23], v[40:41]
    v_pk_fma_f32 v[26:27], v[26:27], v[26:27], v[40:41]
    v_rcp_f32 v22, v22
    v_rcp_f32 v23, v23
    v_rcp_f32 v26, v26
    v_rcp_f32 v27, v27
    v_pk_fma_f32 v[22:23], v[22:23], v[42:43], v[40:41]
    v_pk_fma_f32 v[26:27], v[26:27], v[42:43], v[40:41]
    v_pk_mul_f32 v[20:21], v[20:21], v[22:23]
    v_pk_mul_f32 v[24:25], v[24:25], v[26:27]
    v_cvt_pk_bf16_f32 v34, v20, v21
    v_cvt_pk_bf16_f32 v35, v24, v25
    buffer_store_dwordx2 v[34:35], v9, s[28:31], s6 offen offset:256 sc1
    v_lshlrev_b32 v16, 16, v50
    v_and_b32 v17, 0xffff0000, v50
    v_lshlrev_b32 v18, 16, v51
    v_and_b32 v19, 0xffff0000, v51
    v_cvt_pk_bf16_f32 v28, v80, v81
    v_cvt_pk_bf16_f32 v29, v82, v83
    v_lshlrev_b32 v20, 16, v28
    v_and_b32 v21, 0xffff0000, v28
    v_lshlrev_b32 v24, 16, v29
    v_and_b32 v25, 0xffff0000, v29
    v_pk_add_f32 v[20:21], v[20:21], v[16:17]
    v_pk_add_f32 v[24:25], v[24:25], v[18:19]
    v_cvt_pk_bf16_f32 v28, v20, v21
    v_cvt_pk_bf16_f32 v29, v24, v25
    v_lshlrev_b32 v20, 16, v28
    v_and_b32 v21, 0xffff0000, v28
    v_lshlrev_b32 v24, 16, v29
    v_and_b32 v25, 0xffff0000, v29
    v_pk_mul_f32 v[22:23], v[20:21], s[46:47]
    v_pk_mul_f32 v[26:27], v[24:25], s[46:47]
    v_exp_f32 v22, v22
    v_exp_f32 v23, v23
    v_exp_f32 v26, v26
    v_exp_f32 v27, v27
    v_pk_add_f32 v[22:23], v[22:23], v[40:41]
    v_pk_add_f32 v[26:27], v[26:27], v[40:41]
    v_pk_fma_f32 v[22:23], v[22:23], v[22:23], v[40:41]
    v_pk_fma_f32 v[26:27], v[26:27], v[26:27], v[40:41]
    v_rcp_f32 v22, v22
    v_rcp_f32 v23, v23
    v_rcp_f32 v26, v26
    v_rcp_f32 v27, v27
    v_pk_fma_f32 v[22:23], v[22:23], v[42:43], v[40:41]
    v_pk_fma_f32 v[26:27], v[26:27], v[42:43], v[40:41]
    v_pk_mul_f32 v[20:21], v[20:21], v[22:23]
    v_pk_mul_f32 v[24:25], v[24:25], v[26:27]
    v_cvt_pk_bf16_f32 v36, v20, v21
    v_cvt_pk_bf16_f32 v37, v24, v25
    buffer_store_dwordx2 v[36:37], v9, s[28:31], s6 offen offset:1024 sc1
    v_cvt_pk_bf16_f32 v28, v84, v85
    v_cvt_pk_bf16_f32 v29, v86, v87
    v_lshlrev_b32 v20, 16, v28
    v_and_b32 v21, 0xffff0000, v28
    v_lshlrev_b32 v24, 16, v29
    v_and_b32 v25, 0xffff0000, v29
    v_pk_add_f32 v[20:21], v[20:21], v[16:17]
    v_pk_add_f32 v[24:25], v[24:25], v[18:19]
    v_cvt_pk_bf16_f32 v28, v20, v21
    v_cvt_pk_bf16_f32 v29, v24, v25
    v_lshlrev_b32 v20, 16, v28
    v_and_b32 v21, 0xffff0000, v28
    v_lshlrev_b32 v24, 16, v29
    v_and_b32 v25, 0xffff0000, v29
    v_pk_mul_f32 v[22:23], v[20:21], s[46:47]
    v_pk_mul_f32 v[26:27], v[24:25], s[46:47]
    v_exp_f32 v22, v22
    v_exp_f32 v23, v23
    v_exp_f32 v26, v26
    v_exp_f32 v27, v27
    v_pk_add_f32 v[22:23], v[22:23], v[40:41]
    v_pk_add_f32 v[26:27], v[26:27], v[40:41]
    v_pk_fma_f32 v[22:23], v[22:23], v[22:23], v[40:41]
    v_pk_fma_f32 v[26:27], v[26:27], v[26:27], v[40:41]
    v_rcp_f32 v22, v22
    v_rcp_f32 v23, v23
    v_rcp_f32 v26, v26
    v_rcp_f32 v27, v27
    v_pk_fma_f32 v[22:23], v[22:23], v[42:43], v[40:41]
    v_pk_fma_f32 v[26:27], v[26:27], v[42:43], v[40:41]
    v_pk_mul_f32 v[20:21], v[20:21], v[22:23]
    v_pk_mul_f32 v[24:25], v[24:25], v[26:27]
    v_cvt_pk_bf16_f32 v38, v20, v21
    v_cvt_pk_bf16_f32 v39, v24, v25
    buffer_store_dwordx2 v[38:39], v9, s[28:31], s6 offen offset:1280 sc1
    v_lshlrev_b32 v16, 16, v52
    v_and_b32 v17, 0xffff0000, v52
    v_lshlrev_b32 v18, 16, v53
    v_and_b32 v19, 0xffff0000, v53
    v_cvt_pk_bf16_f32 v28, v88, v89
    v_cvt_pk_bf16_f32 v29, v90, v91
    v_lshlrev_b32 v20, 16, v28
    v_and_b32 v21, 0xffff0000, v28
    v_lshlrev_b32 v24, 16, v29
    v_and_b32 v25, 0xffff0000, v29
    v_pk_add_f32 v[20:21], v[20:21], v[16:17]
    v_pk_add_f32 v[24:25], v[24:25], v[18:19]
    v_cvt_pk_bf16_f32 v28, v20, v21
    v_cvt_pk_bf16_f32 v29, v24, v25
    v_lshlrev_b32 v20, 16, v28
    v_and_b32 v21, 0xffff0000, v28
    v_lshlrev_b32 v24, 16, v29
    v_and_b32 v25, 0xffff0000, v29
    v_pk_mul_f32 v[22:23], v[20:21], s[46:47]
    v_pk_mul_f32 v[26:27], v[24:25], s[46:47]
    v_exp_f32 v22, v22
    v_exp_f32 v23, v23
    v_exp_f32 v26, v26
    v_exp_f32 v27, v27
    v_pk_add_f32 v[22:23], v[22:23], v[40:41]
    v_pk_add_f32 v[26:27], v[26:27], v[40:41]
    v_pk_fma_f32 v[22:23], v[22:23], v[22:23], v[40:41]
    v_pk_fma_f32 v[26:27], v[26:27], v[26:27], v[40:41]
    v_rcp_f32 v22, v22
    v_rcp_f32 v23, v23
    v_rcp_f32 v26, v26
    v_rcp_f32 v27, v27
    v_pk_fma_f32 v[22:23], v[22:23], v[42:43], v[40:41]
    v_pk_fma_f32 v[26:27], v[26:27], v[42:43], v[40:41]
    v_pk_mul_f32 v[20:21], v[20:21], v[22:23]
    v_pk_mul_f32 v[24:25], v[24:25], v[26:27]
    v_cvt_pk_bf16_f32 v32, v20, v21
    v_cvt_pk_bf16_f32 v33, v24, v25
    buffer_store_dwordx2 v[32:33], v9, s[28:31], s6 offen offset:2048 sc1
    v_cvt_pk_bf16_f32 v28, v92, v93
    v_cvt_pk_bf16_f32 v29, v94, v95
    v_lshlrev_b32 v20, 16, v28
    v_and_b32 v21, 0xffff0000, v28
    v_lshlrev_b32 v24, 16, v29
    v_and_b32 v25, 0xffff0000, v29
    v_pk_add_f32 v[20:21], v[20:21], v[16:17]
    v_pk_add_f32 v[24:25], v[24:25], v[18:19]
    v_cvt_pk_bf16_f32 v28, v20, v21
    v_cvt_pk_bf16_f32 v29, v24, v25
    v_lshlrev_b32 v20, 16, v28
    v_and_b32 v21, 0xffff0000, v28
    v_lshlrev_b32 v24, 16, v29
    v_and_b32 v25, 0xffff0000, v29
    v_pk_mul_f32 v[22:23], v[20:21], s[46:47]
    v_pk_mul_f32 v[26:27], v[24:25], s[46:47]
    v_exp_f32 v22, v22
    v_exp_f32 v23, v23
    v_exp_f32 v26, v26
    v_exp_f32 v27, v27
    v_pk_add_f32 v[22:23], v[22:23], v[40:41]
    v_pk_add_f32 v[26:27], v[26:27], v[40:41]
    v_pk_fma_f32 v[22:23], v[22:23], v[22:23], v[40:41]
    v_pk_fma_f32 v[26:27], v[26:27], v[26:27], v[40:41]
    v_rcp_f32 v22, v22
    v_rcp_f32 v23, v23
    v_rcp_f32 v26, v26
    v_rcp_f32 v27, v27
    v_pk_fma_f32 v[22:23], v[22:23], v[42:43], v[40:41]
    v_pk_fma_f32 v[26:27], v[26:27], v[42:43], v[40:41]
    v_pk_mul_f32 v[20:21], v[20:21], v[22:23]
    v_pk_mul_f32 v[24:25], v[24:25], v[26:27]
    v_cvt_pk_bf16_f32 v34, v20, v21
    v_cvt_pk_bf16_f32 v35, v24, v25
    buffer_store_dwordx2 v[34:35], v9, s[28:31], s6 offen offset:2304 sc1
    v_lshlrev_b32 v16, 16, v54
    v_and_b32 v17, 0xffff0000, v54
    v_lshlrev_b32 v18, 16, v55
    v_and_b32 v19, 0xffff0000, v55
    v_cvt_pk_bf16_f32 v28, v96, v97
    v_cvt_pk_bf16_f32 v29, v98, v99
    v_lshlrev_b32 v20, 16, v28
    v_and_b32 v21, 0xffff0000, v28
    v_lshlrev_b32 v24, 16, v29
    v_and_b32 v25, 0xffff0000, v29
    v_pk_add_f32 v[20:21], v[20:21], v[16:17]
    v_pk_add_f32 v[24:25], v[24:25], v[18:19]
    v_cvt_pk_bf16_f32 v28, v20, v21
    v_cvt_pk_bf16_f32 v29, v24, v25
    v_lshlrev_b32 v20, 16, v28
    v_and_b32 v21, 0xffff0000, v28
    v_lshlrev_b32 v24, 16, v29
    v_and_b32 v25, 0xffff0000, v29
    v_pk_mul_f32 v[22:23], v[20:21], s[46:47]
    v_pk_mul_f32 v[26:27], v[24:25], s[46:47]
    v_exp_f32 v22, v22
    v_exp_f32 v23, v23
    v_exp_f32 v26, v26
    v_exp_f32 v27, v27
    v_pk_add_f32 v[22:23], v[22:23], v[40:41]
    v_pk_add_f32 v[26:27], v[26:27], v[40:41]
    v_pk_fma_f32 v[22:23], v[22:23], v[22:23], v[40:41]
    v_pk_fma_f32 v[26:27], v[26:27], v[26:27], v[40:41]
    v_rcp_f32 v22, v22
    v_rcp_f32 v23, v23
    v_rcp_f32 v26, v26
    v_rcp_f32 v27, v27
    v_pk_fma_f32 v[22:23], v[22:23], v[42:43], v[40:41]
    v_pk_fma_f32 v[26:27], v[26:27], v[42:43], v[40:41]
    v_pk_mul_f32 v[20:21], v[20:21], v[22:23]
    v_pk_mul_f32 v[24:25], v[24:25], v[26:27]
    v_cvt_pk_bf16_f32 v36, v20, v21
    v_cvt_pk_bf16_f32 v37, v24, v25
    buffer_store_dwordx2 v[36:37], v9, s[28:31], s6 offen offset:3072 sc1
    v_cvt_pk_bf16_f32 v28, v100, v101
    v_cvt_pk_bf16_f32 v29, v102, v103
    v_lshlrev_b32 v20, 16, v28
    v_and_b32 v21, 0xffff0000, v28
    v_lshlrev_b32 v24, 16, v29
    v_and_b32 v25, 0xffff0000, v29
    v_pk_add_f32 v[20:21], v[20:21], v[16:17]
    v_pk_add_f32 v[24:25], v[24:25], v[18:19]
    v_cvt_pk_bf16_f32 v28, v20, v21
    v_cvt_pk_bf16_f32 v29, v24, v25
    v_lshlrev_b32 v20, 16, v28
    v_and_b32 v21, 0xffff0000, v28
    v_lshlrev_b32 v24, 16, v29
    v_and_b32 v25, 0xffff0000, v29
    v_pk_mul_f32 v[22:23], v[20:21], s[46:47]
    v_pk_mul_f32 v[26:27], v[24:25], s[46:47]
    v_exp_f32 v22, v22
    v_exp_f32 v23, v23
    v_exp_f32 v26, v26
    v_exp_f32 v27, v27
    v_pk_add_f32 v[22:23], v[22:23], v[40:41]
    v_pk_add_f32 v[26:27], v[26:27], v[40:41]
    v_pk_fma_f32 v[22:23], v[22:23], v[22:23], v[40:41]
    v_pk_fma_f32 v[26:27], v[26:27], v[26:27], v[40:41]
    v_rcp_f32 v22, v22
    v_rcp_f32 v23, v23
    v_rcp_f32 v26, v26
    v_rcp_f32 v27, v27
    v_pk_fma_f32 v[22:23], v[22:23], v[42:43], v[40:41]
    v_pk_fma_f32 v[26:27], v[26:27], v[42:43], v[40:41]
    v_pk_mul_f32 v[20:21], v[20:21], v[22:23]
    v_pk_mul_f32 v[24:25], v[24:25], v[26:27]
    v_cvt_pk_bf16_f32 v38, v20, v21
    v_cvt_pk_bf16_f32 v39, v24, v25
    buffer_store_dwordx2 v[38:39], v9, s[28:31], s6 offen offset:3328 sc1
    s_add_u32 s6, s6, 4096
    v_lshlrev_b32 v16, 16, v56
    v_and_b32 v17, 0xffff0000, v56
    v_lshlrev_b32 v18, 16, v57
    v_and_b32 v19, 0xffff0000, v57
    v_cvt_pk_bf16_f32 v28, v104, v105
    v_cvt_pk_bf16_f32 v29, v106, v107
    v_lshlrev_b32 v20, 16, v28
    v_and_b32 v21, 0xffff0000, v28
    v_lshlrev_b32 v24, 16, v29
    v_and_b32 v25, 0xffff0000, v29
    v_pk_add_f32 v[20:21], v[20:21], v[16:17]
    v_pk_add_f32 v[24:25], v[24:25], v[18:19]
    v_cvt_pk_bf16_f32 v28, v20, v21
    v_cvt_pk_bf16_f32 v29, v24, v25
    v_lshlrev_b32 v20, 16, v28
    v_and_b32 v21, 0xffff0000, v28
    v_lshlrev_b32 v24, 16, v29
    v_and_b32 v25, 0xffff0000, v29
    v_pk_mul_f32 v[22:23], v[20:21], s[46:47]
    v_pk_mul_f32 v[26:27], v[24:25], s[46:47]
    v_exp_f32 v22, v22
    v_exp_f32 v23, v23
    v_exp_f32 v26, v26
    v_exp_f32 v27, v27
    v_pk_add_f32 v[22:23], v[22:23], v[40:41]
    v_pk_add_f32 v[26:27], v[26:27], v[40:41]
    v_pk_fma_f32 v[22:23], v[22:23], v[22:23], v[40:41]
    v_pk_fma_f32 v[26:27], v[26:27], v[26:27], v[40:41]
    v_rcp_f32 v22, v22
    v_rcp_f32 v23, v23
    v_rcp_f32 v26, v26
    v_rcp_f32 v27, v27
    v_pk_fma_f32 v[22:23], v[22:23], v[42:43], v[40:41]
    v_pk_fma_f32 v[26:27], v[26:27], v[42:43], v[40:41]
    v_pk_mul_f32 v[20:21], v[20:21], v[22:23]
    v_pk_mul_f32 v[24:25], v[24:25], v[26:27]
    v_cvt_pk_bf16_f32 v32, v20, v21
    v_cvt_pk_bf16_f32 v33, v24, v25
    buffer_store_dwordx2 v[32:33], v9, s[28:31], s6 offen offset:0 sc1
    v_cvt_pk_bf16_f32 v28, v108, v109
    v_cvt_pk_bf16_f32 v29, v110, v111
    v_lshlrev_b32 v20, 16, v28
    v_and_b32 v21, 0xffff0000, v28
    v_lshlrev_b32 v24, 16, v29
    v_and_b32 v25, 0xffff0000, v29
    v_pk_add_f32 v[20:21], v[20:21], v[16:17]
    v_pk_add_f32 v[24:25], v[24:25], v[18:19]
    v_cvt_pk_bf16_f32 v28, v20, v21
    v_cvt_pk_bf16_f32 v29, v24, v25
    v_lshlrev_b32 v20, 16, v28
    v_and_b32 v21, 0xffff0000, v28
    v_lshlrev_b32 v24, 16, v29
    v_and_b32 v25, 0xffff0000, v29
    v_pk_mul_f32 v[22:23], v[20:21], s[46:47]
    v_pk_mul_f32 v[26:27], v[24:25], s[46:47]
    v_exp_f32 v22, v22
    v_exp_f32 v23, v23
    v_exp_f32 v26, v26
    v_exp_f32 v27, v27
    v_pk_add_f32 v[22:23], v[22:23], v[40:41]
    v_pk_add_f32 v[26:27], v[26:27], v[40:41]
    v_pk_fma_f32 v[22:23], v[22:23], v[22:23], v[40:41]
    v_pk_fma_f32 v[26:27], v[26:27], v[26:27], v[40:41]
    v_rcp_f32 v22, v22
    v_rcp_f32 v23, v23
    v_rcp_f32 v26, v26
    v_rcp_f32 v27, v27
    v_pk_fma_f32 v[22:23], v[22:23], v[42:43], v[40:41]
    v_pk_fma_f32 v[26:27], v[26:27], v[42:43], v[40:41]
    v_pk_mul_f32 v[20:21], v[20:21], v[22:23]
    v_pk_mul_f32 v[24:25], v[24:25], v[26:27]
    v_cvt_pk_bf16_f32 v34, v20, v21
    v_cvt_pk_bf16_f32 v35, v24, v25
    buffer_store_dwordx2 v[34:35], v9, s[28:31], s6 offen offset:256 sc1
    v_lshlrev_b32 v16, 16, v58
    v_and_b32 v17, 0xffff0000, v58
    v_lshlrev_b32 v18, 16, v59
    v_and_b32 v19, 0xffff0000, v59
    v_cvt_pk_bf16_f32 v28, v112, v113
    v_cvt_pk_bf16_f32 v29, v114, v115
    v_lshlrev_b32 v20, 16, v28
    v_and_b32 v21, 0xffff0000, v28
    v_lshlrev_b32 v24, 16, v29
    v_and_b32 v25, 0xffff0000, v29
    v_pk_add_f32 v[20:21], v[20:21], v[16:17]
    v_pk_add_f32 v[24:25], v[24:25], v[18:19]
    v_cvt_pk_bf16_f32 v28, v20, v21
    v_cvt_pk_bf16_f32 v29, v24, v25
    v_lshlrev_b32 v20, 16, v28
    v_and_b32 v21, 0xffff0000, v28
    v_lshlrev_b32 v24, 16, v29
    v_and_b32 v25, 0xffff0000, v29
    v_pk_mul_f32 v[22:23], v[20:21], s[46:47]
    v_pk_mul_f32 v[26:27], v[24:25], s[46:47]
    v_exp_f32 v22, v22
    v_exp_f32 v23, v23
    v_exp_f32 v26, v26
    v_exp_f32 v27, v27
    v_pk_add_f32 v[22:23], v[22:23], v[40:41]
    v_pk_add_f32 v[26:27], v[26:27], v[40:41]
    v_pk_fma_f32 v[22:23], v[22:23], v[22:23], v[40:41]
    v_pk_fma_f32 v[26:27], v[26:27], v[26:27], v[40:41]
    v_rcp_f32 v22, v22
    v_rcp_f32 v23, v23
    v_rcp_f32 v26, v26
    v_rcp_f32 v27, v27
    v_pk_fma_f32 v[22:23], v[22:23], v[42:43], v[40:41]
    v_pk_fma_f32 v[26:27], v[26:27], v[42:43], v[40:41]
    v_pk_mul_f32 v[20:21], v[20:21], v[22:23]
    v_pk_mul_f32 v[24:25], v[24:25], v[26:27]
    v_cvt_pk_bf16_f32 v36, v20, v21
    v_cvt_pk_bf16_f32 v37, v24, v25
    buffer_store_dwordx2 v[36:37], v9, s[28:31], s6 offen offset:1024 sc1
    v_cvt_pk_bf16_f32 v28, v116, v117
    v_cvt_pk_bf16_f32 v29, v118, v119
    v_lshlrev_b32 v20, 16, v28
    v_and_b32 v21, 0xffff0000, v28
    v_lshlrev_b32 v24, 16, v29
    v_and_b32 v25, 0xffff0000, v29
    v_pk_add_f32 v[20:21], v[20:21], v[16:17]
    v_pk_add_f32 v[24:25], v[24:25], v[18:19]
    v_cvt_pk_bf16_f32 v28, v20, v21
    v_cvt_pk_bf16_f32 v29, v24, v25
    v_lshlrev_b32 v20, 16, v28
    v_and_b32 v21, 0xffff0000, v28
    v_lshlrev_b32 v24, 16, v29
    v_and_b32 v25, 0xffff0000, v29
    v_pk_mul_f32 v[22:23], v[20:21], s[46:47]
    v_pk_mul_f32 v[26:27], v[24:25], s[46:47]
    v_exp_f32 v22, v22
    v_exp_f32 v23, v23
    v_exp_f32 v26, v26
    v_exp_f32 v27, v27
    v_pk_add_f32 v[22:23], v[22:23], v[40:41]
    v_pk_add_f32 v[26:27], v[26:27], v[40:41]
    v_pk_fma_f32 v[22:23], v[22:23], v[22:23], v[40:41]
    v_pk_fma_f32 v[26:27], v[26:27], v[26:27], v[40:41]
    v_rcp_f32 v22, v22
    v_rcp_f32 v23, v23
    v_rcp_f32 v26, v26
    v_rcp_f32 v27, v27
    v_pk_fma_f32 v[22:23], v[22:23], v[42:43], v[40:41]
    v_pk_fma_f32 v[26:27], v[26:27], v[42:43], v[40:41]
    v_pk_mul_f32 v[20:21], v[20:21], v[22:23]
    v_pk_mul_f32 v[24:25], v[24:25], v[26:27]
    v_cvt_pk_bf16_f32 v38, v20, v21
    v_cvt_pk_bf16_f32 v39, v24, v25
    buffer_store_dwordx2 v[38:39], v9, s[28:31], s6 offen offset:1280 sc1
    s_cmp_lt_u32 s26, 7
    s_cbranch_scc1 g1_end
    v_lshlrev_b32 v16, 16, v60
    v_and_b32 v17, 0xffff0000, v60
    v_lshlrev_b32 v18, 16, v61
    v_and_b32 v19, 0xffff0000, v61
    v_cvt_pk_bf16_f32 v28, v120, v121
    v_cvt_pk_bf16_f32 v29, v122, v123
    v_lshlrev_b32 v20, 16, v28
    v_and_b32 v21, 0xffff0000, v28
    v_lshlrev_b32 v24, 16, v29
    v_and_b32 v25, 0xffff0000, v29
    v_pk_add_f32 v[20:21], v[20:21], v[16:17]
    v_pk_add_f32 v[24:25], v[24:25], v[18:19]
    v_cvt_pk_bf16_f32 v28, v20, v21
    v_cvt_pk_bf16_f32 v29, v24, v25
    v_lshlrev_b32 v20, 16, v28
    v_and_b32 v21, 0xffff0000, v28
    v_lshlrev_b32 v24, 16, v29
    v_and_b32 v25, 0xffff0000, v29
    v_pk_mul_f32 v[22:23], v[20:21], s[46:47]
    v_pk_mul_f32 v[26:27], v[24:25], s[46:47]
    v_exp_f32 v22, v22
    v_exp_f32 v23, v23
    v_exp_f32 v26, v26
    v_exp_f32 v27, v27
    v_pk_add_f32 v[22:23], v[22:23], v[40:41]
    v_pk_add_f32 v[26:27], v[26:27], v[40:41]
    v_pk_fma_f32 v[22:23], v[22:23], v[22:23], v[40:41]
    v_pk_fma_f32 v[26:27], v[26:27], v[26:27], v[40:41]
    v_rcp_f32 v22, v22
    v_rcp_f32 v23, v23
    v_rcp_f32 v26, v26
    v_rcp_f32 v27, v27
    v_pk_fma_f32 v[22:23], v[22:23], v[42:43], v[40:41]
    v_pk_fma_f32 v[26:27], v[26:27], v[42:43], v[40:41]
    v_pk_mul_f32 v[20:21], v[20:21], v[22:23]
    v_pk_mul_f32 v[24:25], v[24:25], v[26:27]
    v_cvt_pk_bf16_f32 v32, v20, v21
    v_cvt_pk_bf16_f32 v33, v24, v25
    buffer_store_dwordx2 v[32:33], v9, s[28:31], s6 offen offset:2048 sc1
    v_cvt_pk_bf16_f32 v28, v124, v125
    v_cvt_pk_bf16_f32 v29, v126, v127
    v_lshlrev_b32 v20, 16, v28
    v_and_b32 v21, 0xffff0000, v28
    v_lshlrev_b32 v24, 16, v29
    v_and_b32 v25, 0xffff0000, v29
    v_pk_add_f32 v[20:21], v[20:21], v[16:17]
    v_pk_add_f32 v[24:25], v[24:25], v[18:19]
    v_cvt_pk_bf16_f32 v28, v20, v21
    v_cvt_pk_bf16_f32 v29, v24, v25
    v_lshlrev_b32 v20, 16, v28
    v_and_b32 v21, 0xffff0000, v28
    v_lshlrev_b32 v24, 16, v29
    v_and_b32 v25, 0xffff0000, v29
    v_pk_mul_f32 v[22:23], v[20:21], s[46:47]
    v_pk_mul_f32 v[26:27], v[24:25], s[46:47]
    v_exp_f32 v22, v22
    v_exp_f32 v23, v23
    v_exp_f32 v26, v26
    v_exp_f32 v27, v27
    v_pk_add_f32 v[22:23], v[22:23], v[40:41]
    v_pk_add_f32 v[26:27], v[26:27], v[40:41]
    v_pk_fma_f32 v[22:23], v[22:23], v[22:23], v[40:41]
    v_pk_fma_f32 v[26:27], v[26:27], v[26:27], v[40:41]
    v_rcp_f32 v22, v22
    v_rcp_f32 v23, v23
    v_rcp_f32 v26, v26
    v_rcp_f32 v27, v27
    v_pk_fma_f32 v[22:23], v[22:23], v[42:43], v[40:41]
    v_pk_fma_f32 v[26:27], v[26:27], v[42:43], v[40:41]
    v_pk_mul_f32 v[20:21], v[20:21], v[22:23]
    v_pk_mul_f32 v[24:25], v[24:25], v[26:27]
    v_cvt_pk_bf16_f32 v34, v20, v21
    v_cvt_pk_bf16_f32 v35, v24, v25
    buffer_store_dwordx2 v[34:35], v9, s[28:31], s6 offen offset:2304 sc1
g1_end:
    s_waitcnt vmcnt(0)
    s_barrier
    s_cmp_lg_u32 s3, 0
    s_cbranch_scc1 g1_sig
    s_lshl_b32 s6, s5, 11
    s_add_u32 s6, s6, s88
    s_add_u32 s6, s6, 24379392
    s_mov_b64 exec, 0xffff
    v_mov_b32 v12, 1
    v_lshlrev_b32 v13, 7, v2
    buffer_store_dword v12, v13, s[28:31], s6 offen sc1
    s_mov_b64 exec, -1
g1_sig:
    s_mov_b32 s2, s90
    s_branch fin_body
    s_endpgm
mid_conv:
    s_mov_b32 s8, s60
    s_and_b32 s9, s61, 0xffff
    s_mov_b32 s10, 1280
    s_mov_b32 s11, 0x00020000
    s_sub_u32 s4, s2, 256
    s_and_b32 s5, s4, 7
    s_lshl_b32 s5, s5, 2
    s_bfe_u32 s6, s4, 0x20003
    s_or_b32 s5, s5, s6
    s_andn2_b32 s4, s4, 31
    s_or_b32 s4, s4, s5
    s_mov_b32 s93, s4
    s_lshl_b32 s5, s4, 1
    v_mov_b32 v3, s5
    s_sleep 10
    buffer_load_ushort v1, v3, s[8:11], 0 offen
    s_lshl_b32 s5, s4, 5
    s_add_u32 s5, s5, 2621440
    v_lshrrev_b32 v4, 1, v0
    v_mul_u32_u24 v4, 20480, v4
    v_and_b32 v5, 1, v0
    v_lshl_add_u32 v4, v5, 4, v4
    buffer_load_dwordx4 v[8:11], v4, s[28:31], s5 offen
    v_lshlrev_b32 v4, 4, v0
    s_mul_i32 s6, s4, 4224
    s_add_u32 s6, s6, 10485760
    buffer_load_dwordx4 v[12:15], v4, s[28:31], s6 offen
    buffer_load_dwordx4 v[16:19], v4, s[28:31], s6 offen offset:16
    v_mov_b32 v28, 0
    v_mov_b32 v29, 0
    v_mov_b32 v30, 0
    v_mov_b32 v31, 0
    v_min_u32 v6, 31, v0
    v_lshrrev_b32 v7, 4, v6
    v_and_b32 v6, 15, v6
    v_lshlrev_b32 v6, 4, v6
    v_mul_u32_u24 v7, 2432, v7
    v_add_u32 v6, v6, v7
    s_cmp_lg_u32 s3, 0
    s_cbranch_scc1 cv_nz
    v_add_u32 v6, 33312, v6
    v_subrev_u32 v7, 32, v0
    v_min_u32 v7, 7, v7
    v_lshrrev_b32 v5, 2, v7
    v_mul_u32_u24 v7, 4160, v7
    v_lshl_add_u32 v7, v5, 5, v7
    v_add_u32 v7, 4096, v7
    v_cmp_gt_u32 vcc, 32, v0
    s_nop 1
    v_cndmask_b32 v6, v7, v6, vcc
    s_mov_b32 exec_hi, 0xff
    ds_write_b128 v6, v[28:31]
    s_mov_b32 exec_hi, -1
cv_nz:
    v_lshrrev_b32 v6, 1, v0
    v_lshlrev_b32 v6, 4, v6
    v_and_b32 v7, 1, v0
    v_mul_u32_u24 v7, 2432, v7
    v_add_u32 v6, v6, v7
    s_waitcnt vmcnt(2)
    ds_write_b128 v6, v[8:11] offset:33568
    s_waitcnt vmcnt(0)
    ds_write_b128 v4, v[12:15] offset:0
    v_alignbit_b32 v36, v13, v12, 16
    v_alignbit_b32 v37, v14, v13, 16
    v_alignbit_b32 v38, v15, v14, 16
    v_alignbit_b32 v39, v16, v15, 16
    ds_write_b128 v4, v[36:39] offset:4160
    v_mov_b32 v32, v13
    v_mov_b32 v33, v14
    v_mov_b32 v34, v15
    v_mov_b32 v35, v16
    ds_write_b128 v4, v[32:35] offset:8320
    v_alignbit_b32 v36, v14, v13, 16
    v_alignbit_b32 v37, v15, v14, 16
    v_alignbit_b32 v38, v16, v15, 16
    v_alignbit_b32 v39, v17, v16, 16
    ds_write_b128 v4, v[36:39] offset:12480
    ds_write_b128 v4, v[14:17] offset:16672
    v_alignbit_b32 v36, v15, v14, 16
    v_alignbit_b32 v37, v16, v15, 16
    v_alignbit_b32 v38, v17, v16, 16
    v_alignbit_b32 v39, v18, v17, 16
    ds_write_b128 v4, v[36:39] offset:20832
    v_mov_b32 v32, v15
    v_mov_b32 v33, v16
    v_mov_b32 v34, v17
    v_mov_b32 v35, v18
    ds_write_b128 v4, v[32:35] offset:24992
    v_alignbit_b32 v36, v16, v15, 16
    v_alignbit_b32 v37, v17, v16, 16
    v_alignbit_b32 v38, v18, v17, 16
    v_alignbit_b32 v39, v19, v18, 16
    ds_write_b128 v4, v[36:39] offset:29152
    v_and_b32 v3, 15, v2
    v_lshrrev_b32 v4, 4, v2
    v_sub_u32 v5, 7, v3
    v_and_b32 v5, 7, v5
    v_sub_u32 v6, 2031, v3
    v_lshl_add_u32 v6, v4, 3, v6
    v_sub_u32 v6, v6, v5
    v_mul_u32_u24 v7, 4160, v5
    v_lshrrev_b32 v8, 2, v5
    v_lshl_add_u32 v7, v8, 5, v7
    v_lshl_add_u32 v6, v6, 1, v7
    s_lshl_b32 s5, s3, 7
    s_add_u32 s5, s5, 3648
    v_subrev_u32 v8, s5, v6
    v_and_b32 v5, 1, v4
    v_lshrrev_b32 v6, 1, v4
    v_mul_u32_u24 v7, 2432, v5
    v_add_u32 v9, v3, v6
    v_lshl_add_u32 v9, v9, 4, v7
    s_lshl_b32 s5, s3, 6
    s_sub_u32 s5, 33520, s5
    v_add_u32 v9, s5, v9
    v_mul_u32_u24 v11, 2432, v6
    v_lshl_add_u32 v11, v3, 4, v11
    v_lshl_add_u32 v11, v5, 3, v11
    s_lshl_b32 s5, s3, 9
    v_add_u32 v11, s5, v11
    v_lshlrev_b32 v12, 5, v3
    v_lshl_add_u32 v12, v4, 3, v12
    v_lshlrev_b32 v10, 4, v2
    s_lshl_b32 s5, s3, 13
    v_add_u32 v13, s5, v10
    s_lshl_b32 s5, s3, 10
    v_add_u32 v10, s5, v10
    v_mov_b32 v16, 0
    v_mov_b32 v17, 0
    v_mov_b32 v18, 0
    v_mov_b32 v19, 0
    v_mov_b32 v20, 0
    v_mov_b32 v21, 0
    v_mov_b32 v22, 0
    v_mov_b32 v23, 0
    v_mov_b32 v24, 0
    v_mov_b32 v25, 0
    v_mov_b32 v26, 0
    v_mov_b32 v27, 0
    v_mov_b32 v28, 0
    v_mov_b32 v29, 0
    v_mov_b32 v30, 0
    v_mov_b32 v31, 0
    v_mov_b32 v32, 0
    v_mov_b32 v33, 0
    v_mov_b32 v34, 0
    v_mov_b32 v35, 0
    v_mov_b32 v36, 0
    v_mov_b32 v37, 0
    v_mov_b32 v38, 0
    v_mov_b32 v39, 0
    v_mov_b32 v40, 0
    v_mov_b32 v41, 0
    v_mov_b32 v42, 0
    v_mov_b32 v43, 0
    v_mov_b32 v44, 0
    v_mov_b32 v45, 0
    v_mov_b32 v46, 0
    v_mov_b32 v47, 0
    s_waitcnt lgkmcnt(0)
    s_barrier
    ds_read_b128 v[48:51], v8 offset:3648
    ds_read_b128 v[52:55], v9 offset:1824
    ds_read_b128 v[56:59], v9 offset:32
    ds_read_b128 v[60:63], v8 offset:64
    ds_read_b128 v[64:67], v8 offset:3136
    ds_read_b128 v[68:71], v9 offset:1568
    ds_read_b128 v[72:75], v9 offset:288
    ds_read_b128 v[76:79], v8 offset:576
    ds_read_b128 v[80:83], v8 offset:2624
    ds_read_b128 v[84:87], v9 offset:1312
    ds_read_b128 v[88:91], v9 offset:544
    ds_read_b128 v[92:95], v8 offset:1088
    ds_read_b128 v[96:99], v8 offset:2112
    ds_read_b128 v[100:103], v9 offset:1056
    ds_read_b128 v[104:107], v9 offset:800
    s_waitcnt lgkmcnt(11)
    v_mfma_f32_16x16x32_bf16 v[44:47], v[48:51], v[52:55], v[44:47]
    v_mfma_f32_16x16x32_bf16 v[44:47], v[60:63], v[56:59], v[44:47]
    ds_read_b128 v[108:111], v8 offset:1600
    ds_read_b128 v[112:115], v8 offset:3584
    ds_read_b128 v[116:119], v9 offset:1792
    ds_read_b128 v[120:123], v9 offset:0
    s_waitcnt lgkmcnt(11)
    v_mfma_f32_16x16x32_bf16 v[40:43], v[48:51], v[68:71], v[40:43]
    v_mfma_f32_16x16x32_bf16 v[44:47], v[64:67], v[68:71], v[44:47]
    v_mfma_f32_16x16x32_bf16 v[40:43], v[76:79], v[56:59], v[40:43]
    v_mfma_f32_16x16x32_bf16 v[44:47], v[76:79], v[72:75], v[44:47]
    ds_read_b128 v[124:127], v8 offset:0
    ds_read_b128 v[60:63], v8 offset:3072
    ds_read_b128 v[52:55], v9 offset:1536
    ds_read_b128 v[76:79], v9 offset:256
    s_waitcnt lgkmcnt(11)
    v_mfma_f32_16x16x32_bf16 v[36:39], v[48:51], v[84:87], v[36:39]
    v_mfma_f32_16x16x32_bf16 v[40:43], v[64:67], v[84:87], v[40:43]
    v_mfma_f32_16x16x32_bf16 v[44:47], v[80:83], v[84:87], v[44:47]
    v_mfma_f32_16x16x32_bf16 v[36:39], v[92:95], v[56:59], v[36:39]
    v_mfma_f32_16x16x32_bf16 v[40:43], v[92:95], v[72:75], v[40:43]
    v_mfma_f32_16x16x32_bf16 v[44:47], v[92:95], v[88:91], v[44:47]
    ds_read_b128 v[68:71], v8 offset:512
    ds_read_b128 v[92:95], v8 offset:2560
    ds_read_b128 v[84:87], v9 offset:1280
    s_waitcnt lgkmcnt(10)
    v_mfma_f32_16x16x32_bf16 v[32:35], v[48:51], v[100:103], v[32:35]
    v_mfma_f32_16x16x32_bf16 v[36:39], v[64:67], v[100:103], v[36:39]
    v_mfma_f32_16x16x32_bf16 v[40:43], v[80:83], v[100:103], v[40:43]
    v_mfma_f32_16x16x32_bf16 v[44:47], v[96:99], v[100:103], v[44:47]
    v_mfma_f32_16x16x32_bf16 v[32:35], v[108:111], v[56:59], v[32:35]
    v_mfma_f32_16x16x32_bf16 v[36:39], v[108:111], v[72:75], v[36:39]
    v_mfma_f32_16x16x32_bf16 v[40:43], v[108:111], v[88:91], v[40:43]
    v_mfma_f32_16x16x32_bf16 v[44:47], v[108:111], v[104:107], v[44:47]
    ds_read_b128 v[108:111], v9 offset:512
    ds_read_b128 v[100:103], v8 offset:1024
    v_mfma_f32_16x16x32_bf16 v[28:31], v[48:51], v[104:107], v[28:31]
    v_mfma_f32_16x16x32_bf16 v[32:35], v[64:67], v[104:107], v[32:35]
    v_mfma_f32_16x16x32_bf16 v[36:39], v[80:83], v[104:107], v[36:39]
    v_mfma_f32_16x16x32_bf16 v[40:43], v[96:99], v[104:107], v[40:43]
    v_mfma_f32_16x16x32_bf16 v[28:31], v[96:99], v[56:59], v[28:31]
    v_mfma_f32_16x16x32_bf16 v[32:35], v[96:99], v[72:75], v[32:35]
    v_mfma_f32_16x16x32_bf16 v[36:39], v[96:99], v[88:91], v[36:39]
    ds_read_b128 v[96:99], v8 offset:2048
    ds_read_b128 v[104:107], v9 offset:1024
    v_mfma_f32_16x16x32_bf16 v[24:27], v[48:51], v[88:91], v[24:27]
    v_mfma_f32_16x16x32_bf16 v[28:31], v[64:67], v[88:91], v[28:31]
    v_mfma_f32_16x16x32_bf16 v[32:35], v[80:83], v[88:91], v[32:35]
    v_mfma_f32_16x16x32_bf16 v[24:27], v[80:83], v[56:59], v[24:27]
    v_mfma_f32_16x16x32_bf16 v[28:31], v[80:83], v[72:75], v[28:31]
    ds_read_b128 v[80:83], v9 offset:768
    v_mfma_f32_16x16x32_bf16 v[20:23], v[48:51], v[72:75], v[20:23]
    v_mfma_f32_16x16x32_bf16 v[24:27], v[64:67], v[72:75], v[24:27]
    v_mfma_f32_16x16x32_bf16 v[20:23], v[64:67], v[56:59], v[20:23]
    v_mfma_f32_16x16x32_bf16 v[16:19], v[48:51], v[56:59], v[16:19]
    s_waitcnt lgkmcnt(11)
    v_mfma_f32_16x16x32_bf16 v[44:47], v[112:115], v[116:119], v[44:47]
    v_mfma_f32_16x16x32_bf16 v[44:47], v[124:127], v[120:123], v[44:47]
    ds_read_b128 v[88:91], v8 offset:1536
    s_waitcnt lgkmcnt(8)
    v_mfma_f32_16x16x32_bf16 v[40:43], v[112:115], v[52:55], v[40:43]
    v_mfma_f32_16x16x32_bf16 v[44:47], v[60:63], v[52:55], v[44:47]
    v_mfma_f32_16x16x32_bf16 v[40:43], v[68:71], v[120:123], v[40:43]
    v_mfma_f32_16x16x32_bf16 v[44:47], v[68:71], v[76:79], v[44:47]
    s_waitcnt lgkmcnt(4)
    v_mfma_f32_16x16x32_bf16 v[36:39], v[112:115], v[84:87], v[36:39]
    v_mfma_f32_16x16x32_bf16 v[40:43], v[60:63], v[84:87], v[40:43]
    v_mfma_f32_16x16x32_bf16 v[44:47], v[92:95], v[84:87], v[44:47]
    v_mfma_f32_16x16x32_bf16 v[36:39], v[100:103], v[120:123], v[36:39]
    v_mfma_f32_16x16x32_bf16 v[40:43], v[100:103], v[76:79], v[40:43]
    v_mfma_f32_16x16x32_bf16 v[44:47], v[100:103], v[108:111], v[44:47]
    s_waitcnt lgkmcnt(0)
    v_mfma_f32_16x16x32_bf16 v[32:35], v[112:115], v[104:107], v[32:35]
    v_mfma_f32_16x16x32_bf16 v[36:39], v[60:63], v[104:107], v[36:39]
    v_mfma_f32_16x16x32_bf16 v[40:43], v[92:95], v[104:107], v[40:43]
    v_mfma_f32_16x16x32_bf16 v[44:47], v[96:99], v[104:107], v[44:47]
    v_mfma_f32_16x16x32_bf16 v[32:35], v[88:91], v[120:123], v[32:35]
    v_mfma_f32_16x16x32_bf16 v[36:39], v[88:91], v[76:79], v[36:39]
    v_mfma_f32_16x16x32_bf16 v[40:43], v[88:91], v[108:111], v[40:43]
    v_mfma_f32_16x16x32_bf16 v[44:47], v[88:91], v[80:83], v[44:47]
    v_mfma_f32_16x16x32_bf16 v[28:31], v[112:115], v[80:83], v[28:31]
    v_mfma_f32_16x16x32_bf16 v[32:35], v[60:63], v[80:83], v[32:35]
    v_mfma_f32_16x16x32_bf16 v[36:39], v[92:95], v[80:83], v[36:39]
    v_mfma_f32_16x16x32_bf16 v[40:43], v[96:99], v[80:83], v[40:43]
    v_mfma_f32_16x16x32_bf16 v[28:31], v[96:99], v[120:123], v[28:31]
    v_mfma_f32_16x16x32_bf16 v[32:35], v[96:99], v[76:79], v[32:35]
    v_mfma_f32_16x16x32_bf16 v[36:39], v[96:99], v[108:111], v[36:39]
    v_mfma_f32_16x16x32_bf16 v[24:27], v[112:115], v[108:111], v[24:27]
    v_mfma_f32_16x16x32_bf16 v[28:31], v[60:63], v[108:111], v[28:31]
    v_mfma_f32_16x16x32_bf16 v[32:35], v[92:95], v[108:111], v[32:35]
    v_mfma_f32_16x16x32_bf16 v[24:27], v[92:95], v[120:123], v[24:27]
    v_mfma_f32_16x16x32_bf16 v[28:31], v[92:95], v[76:79], v[28:31]
    v_mfma_f32_16x16x32_bf16 v[20:23], v[112:115], v[76:79], v[20:23]
    v_mfma_f32_16x16x32_bf16 v[24:27], v[60:63], v[76:79], v[24:27]
    v_mfma_f32_16x16x32_bf16 v[20:23], v[60:63], v[120:123], v[20:23]
    v_mfma_f32_16x16x32_bf16 v[16:19], v[112:115], v[120:123], v[16:19]
    s_nop 15
    s_barrier
    ds_write_b128 v10, v[16:19] offset:0
    ds_write_b128 v10, v[20:23] offset:4096
    ds_write_b128 v10, v[24:27] offset:8192
    ds_write_b128 v10, v[28:31] offset:12288
    ds_write_b128 v10, v[32:35] offset:16384
    ds_write_b128 v10, v[36:39] offset:20480
    ds_write_b128 v10, v[40:43] offset:24576
    ds_write_b128 v10, v[44:47] offset:28672
    ds_read_b64 v[80:81], v11 offset:33568
    ds_read_b64 v[82:83], v11 offset:33824
    s_lshl_b32 s5, s4, 12
    s_lshl_b32 s6, s3, 10
    s_add_u32 s5, s5, s6
    s_add_u32 s5, s5, 20971520
    v_lshlrev_b32 v1, 16, v1
    s_waitcnt lgkmcnt(0)
    s_barrier
    ds_read_b128 v[48:51], v13 offset:0
    ds_read_b128 v[52:55], v13 offset:1024
    ds_read_b128 v[56:59], v13 offset:2048
    ds_read_b128 v[60:63], v13 offset:3072
    ds_read_b128 v[64:67], v13 offset:4096
    ds_read_b128 v[68:71], v13 offset:5120
    ds_read_b128 v[72:75], v13 offset:6144
    ds_read_b128 v[76:79], v13 offset:7168
    v_lshlrev_b32 v84, 16, v80
    v_and_b32 v85, 0xffff0000, v80
    v_mul_f32 v84, v84, v1
    v_mul_f32 v85, v85, v1
    v_cvt_pk_bf16_f32 v84, v84, v85
    v_lshlrev_b32 v88, 16, v84
    v_and_b32 v89, 0xffff0000, v84
    v_lshlrev_b32 v84, 16, v81
    v_and_b32 v85, 0xffff0000, v81
    v_mul_f32 v84, v84, v1
    v_mul_f32 v85, v85, v1
    v_cvt_pk_bf16_f32 v84, v84, v85
    v_lshlrev_b32 v90, 16, v84
    v_and_b32 v91, 0xffff0000, v84
    v_lshlrev_b32 v84, 16, v82
    v_and_b32 v85, 0xffff0000, v82
    v_mul_f32 v84, v84, v1
    v_mul_f32 v85, v85, v1
    v_cvt_pk_bf16_f32 v84, v84, v85
    v_lshlrev_b32 v92, 16, v84
    v_and_b32 v93, 0xffff0000, v84
    v_lshlrev_b32 v84, 16, v83
    v_and_b32 v85, 0xffff0000, v83
    v_mul_f32 v84, v84, v1
    v_mul_f32 v85, v85, v1
    v_cvt_pk_bf16_f32 v84, v84, v85
    v_lshlrev_b32 v94, 16, v84
    v_and_b32 v95, 0xffff0000, v84
    s_waitcnt lgkmcnt(4)
    v_add_f32 v48, v48, v52
    v_add_f32 v56, v56, v60
    v_add_f32 v49, v49, v53
    v_add_f32 v57, v57, v61
    v_add_f32 v50, v50, v54
    v_add_f32 v58, v58, v62
    v_add_f32 v51, v51, v55
    v_add_f32 v59, v59, v63
    v_add_f32 v48, v48, v56
    v_add_f32 v49, v49, v57
    v_add_f32 v50, v50, v58
    v_add_f32 v51, v51, v59
    v_cvt_pk_bf16_f32 v84, v48, v49
    v_lshlrev_b32 v85, 16, v84
    v_and_b32 v86, 0xffff0000, v84
    v_add_f32 v85, v85, v88
    v_add_f32 v86, v86, v89
    v_cvt_pk_bf16_f32 v96, v85, v86
    v_cvt_pk_bf16_f32 v84, v50, v51
    v_lshlrev_b32 v85, 16, v84
    v_and_b32 v86, 0xffff0000, v84
    v_add_f32 v85, v85, v90
    v_add_f32 v86, v86, v91
    v_cvt_pk_bf16_f32 v97, v85, v86
    buffer_store_dwordx2 v[96:97], v12, s[28:31], s5 offen offset:0 sc1
    s_waitcnt lgkmcnt(0)
    v_add_f32 v64, v64, v68
    v_add_f32 v72, v72, v76
    v_add_f32 v65, v65, v69
    v_add_f32 v73, v73, v77
    v_add_f32 v66, v66, v70
    v_add_f32 v74, v74, v78
    v_add_f32 v67, v67, v71
    v_add_f32 v75, v75, v79
    v_add_f32 v64, v64, v72
    v_add_f32 v65, v65, v73
    v_add_f32 v66, v66, v74
    v_add_f32 v67, v67, v75
    v_cvt_pk_bf16_f32 v84, v64, v65
    v_lshlrev_b32 v85, 16, v84
    v_and_b32 v86, 0xffff0000, v84
    v_add_f32 v85, v85, v92
    v_add_f32 v86, v86, v93
    v_cvt_pk_bf16_f32 v98, v85, v86
    v_cvt_pk_bf16_f32 v84, v66, v67
    v_lshlrev_b32 v85, 16, v84
    v_and_b32 v86, 0xffff0000, v84
    v_add_f32 v85, v85, v94
    v_add_f32 v86, v86, v95
    v_cvt_pk_bf16_f32 v99, v85, v86
    buffer_store_dwordx2 v[98:99], v12, s[28:31], s5 offen offset:512 sc1
    s_mul_i32 s7, s93, 205
    s_lshr_b32 s7, s7, 14
    s_add_u32 s7, s7, 16
    s_sub_u32 s7, s7, 16
    s_mul_i32 s6, s7, 80
    s_sub_u32 s6, s93, s6
    s_lshl_b32 s6, s6, 2
    s_lshl_b32 s7, s7, 9
    s_add_u32 s6, s6, s7
    s_add_u32 s6, s6, 24641536
    s_waitcnt vmcnt(0)
    s_barrier
    s_cmp_lg_u32 s3, 0
    s_cbranch_scc1 cv_sig
    s_mov_b32 exec_hi, 0
    v_mov_b32 v12, 1
    v_lshlrev_b32 v13, 12, v2
    buffer_store_dword v12, v13, s[28:31], s6 offen sc1
cv_sig:
mid_end:
    s_endpgm
.section .rodata,"a"
.p2align 6
.amdhsa_kernel mid_kernel
  .amdhsa_next_free_vgpr 168
  .amdhsa_next_free_sgpr 96
  .amdhsa_accum_offset 128
  .amdhsa_group_segment_fixed_size 0
  .amdhsa_kernarg_size 112
  .amdhsa_user_sgpr_count 2
  .amdhsa_user_sgpr_kernarg_segment_ptr 1
  .amdhsa_system_sgpr_workgroup_id_x 1
.end_amdhsa_kernel
.text
fin_kernel:
fin_body:
    s_load_dwordx2 s[56:57], s[0:1], 104
    s_load_dwordx2 s[58:59], s[0:1], 0
    s_load_dwordx2 s[60:61], s[0:1], 88
    v_lshrrev_b32 v1, 6, v0
    v_and_b32 v2, 63, v0
    s_nop 0
    v_readfirstlane_b32 s3, v1
    s_lshr_b32 s5, s2, 6
    s_lshl_b32 s5, s5, 3
    s_and_b32 s6, s2, 7
    s_add_u32 s5, s5, s6
    s_bfe_u32 s4, s2, 0x10005
    s_lshl_b32 s4, s4, 2
    s_bfe_u32 s6, s2, 0x20003
    s_add_u32 s4, s4, s6
    v_and_b32 v3, 15, v2
    v_lshrrev_b32 v4, 4, v2
    v_lshrrev_b32 v5, 1, v4
    v_and_b32 v6, 1, v4
    v_lshlrev_b32 v7, 4, v3
    v_lshl_add_u32 v7, v5, 10, v7
    v_lshl_add_u32 v7, v6, 9, v7
    s_lshl_b32 s6, s3, 11
    v_add_u32 v7, s6, v7
    s_mul_i32 s6, s4, 5
    s_add_u32 s7, s6, 0
    s_lshr_b32 s40, s7, 1
    s_mul_i32 s40, s40, 110592
    s_and_b32 s7, s7, 1
    s_lshl_b32 s7, s7, 8
    s_add_u32 s40, s40, s7
    s_add_u32 s40, s40, 7454720
    s_add_u32 s7, s6, 1
    s_lshr_b32 s41, s7, 1
    s_mul_i32 s41, s41, 110592
    s_and_b32 s7, s7, 1
    s_lshl_b32 s7, s7, 8
    s_add_u32 s41, s41, s7
    s_add_u32 s41, s41, 7454720
    s_add_u32 s7, s6, 2
    s_lshr_b32 s42, s7, 1
    s_mul_i32 s42, s42, 110592
    s_and_b32 s7, s7, 1
    s_lshl_b32 s7, s7, 8
    s_add_u32 s42, s42, s7
    s_add_u32 s42, s42, 7454720
    s_add_u32 s7, s6, 3
    s_lshr_b32 s43, s7, 1
    s_mul_i32 s43, s43, 110592
    s_and_b32 s7, s7, 1
    s_lshl_b32 s7, s7, 8
    s_add_u32 s43, s43, s7
    s_add_u32 s43, s43, 7454720
    s_add_u32 s7, s6, 4
    s_lshr_b32 s44, s7, 1
    s_mul_i32 s44, s44, 110592
    s_and_b32 s7, s7, 1
    s_lshl_b32 s7, s7, 8
    s_add_u32 s44, s44, s7
    s_add_u32 s44, s44, 7454720
    s_mul_i32 s6, s5, 221184
    s_add_u32 s45, s6, 13631488
    s_add_u32 s46, s45, 256
    s_add_u32 s47, s45, 110592
    s_add_u32 s48, s47, 256
    s_waitcnt lgkmcnt(0)
    s_mov_b32 s28, s56
    s_and_b32 s29, s57, 0xffff
    s_mov_b32 s30, 268435456
    s_mov_b32 s31, 0x00020000
    s_mov_b32 s8, s58
    s_and_b32 s9, s59, 0xffff
    s_mov_b32 s10, 2621440
    s_mov_b32 s11, 0x00020000
    s_mov_b32 s12, s60
    s_and_b32 s13, s61, 0xffff
    s_mov_b32 s14, 2621440
    s_mov_b32 s15, 0x00020000
    v_mov_b32 v12, v7
    v_mov_b32 v14, 0
    buffer_load_dwordx4 v[16:19], v12, s[28:31], s40 offen
    buffer_load_dwordx4 v[20:23], v12, s[28:31], s41 offen
    buffer_load_dwordx4 v[24:27], v12, s[28:31], s42 offen
    buffer_load_dwordx4 v[28:31], v12, s[28:31], s43 offen
    buffer_load_dwordx4 v[32:35], v12, s[28:31], s44 offen
    v_add_u32 v12, 8192, v12
    buffer_load_dwordx4 v[52:55], v12, s[28:31], s40 offen
    buffer_load_dwordx4 v[56:59], v12, s[28:31], s41 offen
    buffer_load_dwordx4 v[60:63], v12, s[28:31], s42 offen
    buffer_load_dwordx4 v[64:67], v12, s[28:31], s43 offen
    buffer_load_dwordx4 v[68:71], v12, s[28:31], s44 offen
    v_add_u32 v12, 8192, v12
    v_accvgpr_write_b32 a0, 0
    v_accvgpr_write_b32 a1, 0
    v_accvgpr_write_b32 a2, 0
    v_accvgpr_write_b32 a3, 0
    v_accvgpr_write_b32 a4, 0
    v_accvgpr_write_b32 a5, 0
    v_accvgpr_write_b32 a6, 0
    v_accvgpr_write_b32 a7, 0
    v_accvgpr_write_b32 a8, 0
    v_accvgpr_write_b32 a9, 0
    v_accvgpr_write_b32 a10, 0
    v_accvgpr_write_b32 a11, 0
    v_accvgpr_write_b32 a12, 0
    v_accvgpr_write_b32 a13, 0
    v_accvgpr_write_b32 a14, 0
    v_accvgpr_write_b32 a15, 0
    v_accvgpr_write_b32 a16, 0
    v_accvgpr_write_b32 a17, 0
    v_accvgpr_write_b32 a18, 0
    v_accvgpr_write_b32 a19, 0
    v_accvgpr_write_b32 a20, 0
    v_accvgpr_write_b32 a21, 0
    v_accvgpr_write_b32 a22, 0
    v_accvgpr_write_b32 a23, 0
    v_accvgpr_write_b32 a24, 0
    v_accvgpr_write_b32 a25, 0
    v_accvgpr_write_b32 a26, 0
    v_accvgpr_write_b32 a27, 0
    v_accvgpr_write_b32 a28, 0
    v_accvgpr_write_b32 a29, 0
    v_accvgpr_write_b32 a30, 0
    v_accvgpr_write_b32 a31, 0
    v_accvgpr_write_b32 a32, 0
    v_accvgpr_write_b32 a33, 0
    v_accvgpr_write_b32 a34, 0
    v_accvgpr_write_b32 a35, 0
    v_accvgpr_write_b32 a36, 0
    v_accvgpr_write_b32 a37, 0
    v_accvgpr_write_b32 a38, 0
    v_accvgpr_write_b32 a39, 0
    v_mov_b32 v88, 0
    v_mov_b32 v89, 0
    v_mov_b32 v90, 0
    v_mov_b32 v91, 0
    v_mov_b32 v92, 0
    v_mov_b32 v93, 0
    v_mov_b32 v94, 0
    v_mov_b32 v95, 0
    v_mov_b32 v96, 0
    v_mov_b32 v97, 0
    v_mov_b32 v98, 0
    v_mov_b32 v99, 0
    v_mov_b32 v100, 0
    v_mov_b32 v101, 0
    v_mov_b32 v102, 0
    v_mov_b32 v103, 0
    v_mov_b32 v104, 0
    v_mov_b32 v105, 0
    v_mov_b32 v106, 0
    v_mov_b32 v107, 0
    v_mov_b32 v108, 0
    v_mov_b32 v109, 0
    v_mov_b32 v110, 0
    v_mov_b32 v111, 0
    v_mov_b32 v112, 0
    v_mov_b32 v113, 0
    v_mov_b32 v114, 0
    v_mov_b32 v115, 0
    v_mov_b32 v116, 0
    v_mov_b32 v117, 0
    v_mov_b32 v118, 0
    v_mov_b32 v119, 0
    v_mov_b32 v120, 0
    v_mov_b32 v121, 0
    v_mov_b32 v122, 0
    v_mov_b32 v123, 0
    v_mov_b32 v124, 0
    v_mov_b32 v125, 0
    v_mov_b32 v126, 0
    v_mov_b32 v127, 0
    s_lshr_b32 s6, s5, 1
    s_lshl_b32 s6, s6, 12
    s_add_u32 s6, s6, 24117248
    s_lshl_b32 s94, s4, 12
    s_add_u32 s94, s94, 24182784
    s_cmp_lg_u32 s3, 0
    s_cbranch_scc1 fp0_d
    s_lshl_b32 s6, s5, 3
    s_add_u32 s6, s6, s4
    s_lshl_b32 s6, s6, 7
    s_add_u32 s6, s6, 24379392
    v_lshlrev_b32 v15, 2, v3
    s_mov_b32 s91, 0
fp0_p:
    buffer_load_dword v13, v15, s[28:31], s6 offen sc0 sc1
    s_waitcnt vmcnt(0)
    v_cmp_ne_u32 vcc, 1, v13
    s_cmp_eq_u64 vcc, 0
    s_cbranch_scc1 fp0_d
    s_add_u32 s91, s91, 1
    s_cmp_ge_u32 s91, 0x20000
    s_cbranch_scc1 fp0_d
    s_sleep 6
    s_branch fp0_p
fp0_d:
    s_barrier
    buffer_load_dwordx4 v[36:39], v7, s[28:31], s45 offen
    buffer_load_dwordx4 v[40:43], v7, s[28:31], s46 offen
    buffer_load_dwordx4 v[44:47], v7, s[28:31], s47 offen
    buffer_load_dwordx4 v[48:51], v7, s[28:31], s48 offen
    v_add_u32 v7, 8192, v7
    buffer_load_dwordx4 v[72:75], v7, s[28:31], s45 offen
    buffer_load_dwordx4 v[76:79], v7, s[28:31], s46 offen
    buffer_load_dwordx4 v[80:83], v7, s[28:31], s47 offen
    buffer_load_dwordx4 v[84:87], v7, s[28:31], s48 offen
    v_add_u32 v7, 8192, v7
    s_lshl_b32 s6, s5, 6
    s_lshl_b32 s7, s3, 4
    s_add_u32 s6, s6, s7
    v_add_u32 v8, s6, v3
    v_mul_u32_u24 v9, 1280, v8
    v_lshl_add_u32 v9, v4, 3, v9
    s_mul_i32 s6, s4, 160
    v_add_u32 v9, s6, v9
    s_waitcnt vmcnt(4)
    v_mfma_f32_16x16x32_bf16 a[0:3], v[16:19], v[36:39], a[0:3]
    v_mfma_f32_16x16x32_bf16 a[4:7], v[20:23], v[36:39], a[4:7]
    v_mfma_f32_16x16x32_bf16 a[8:11], v[24:27], v[36:39], a[8:11]
    v_mfma_f32_16x16x32_bf16 a[12:15], v[28:31], v[36:39], a[12:15]
    v_mfma_f32_16x16x32_bf16 a[16:19], v[32:35], v[36:39], a[16:19]
    v_mfma_f32_16x16x32_bf16 a[20:23], v[16:19], v[40:43], a[20:23]
    v_mfma_f32_16x16x32_bf16 a[24:27], v[20:23], v[40:43], a[24:27]
    v_mfma_f32_16x16x32_bf16 a[28:31], v[24:27], v[40:43], a[28:31]
    v_mfma_f32_16x16x32_bf16 a[32:35], v[28:31], v[40:43], a[32:35]
    v_mfma_f32_16x16x32_bf16 a[36:39], v[32:35], v[40:43], a[36:39]
    v_mfma_f32_16x16x32_bf16 v[88:91], v[16:19], v[44:47], v[88:91]
    v_mfma_f32_16x16x32_bf16 v[92:95], v[20:23], v[44:47], v[92:95]
    v_mfma_f32_16x16x32_bf16 v[96:99], v[24:27], v[44:47], v[96:99]
    v_mfma_f32_16x16x32_bf16 v[100:103], v[28:31], v[44:47], v[100:103]
    v_mfma_f32_16x16x32_bf16 v[104:107], v[32:35], v[44:47], v[104:107]
    v_mfma_f32_16x16x32_bf16 v[108:111], v[16:19], v[48:51], v[108:111]
    v_mfma_f32_16x16x32_bf16 v[112:115], v[20:23], v[48:51], v[112:115]
    v_mfma_f32_16x16x32_bf16 v[116:119], v[24:27], v[48:51], v[116:119]
    v_mfma_f32_16x16x32_bf16 v[120:123], v[28:31], v[48:51], v[120:123]
    v_mfma_f32_16x16x32_bf16 v[124:127], v[32:35], v[48:51], v[124:127]
    buffer_load_dwordx4 v[16:19], v7, s[28:31], s40 offen
    buffer_load_dwordx4 v[20:23], v7, s[28:31], s41 offen
    buffer_load_dwordx4 v[24:27], v7, s[28:31], s42 offen
    buffer_load_dwordx4 v[28:31], v7, s[28:31], s43 offen
    buffer_load_dwordx4 v[32:35], v7, s[28:31], s44 offen
    buffer_load_dwordx4 v[36:39], v7, s[28:31], s45 offen
    buffer_load_dwordx4 v[40:43], v7, s[28:31], s46 offen
    buffer_load_dwordx4 v[44:47], v7, s[28:31], s47 offen
    buffer_load_dwordx4 v[48:51], v7, s[28:31], s48 offen
    v_add_u32 v7, 8192, v7
    s_waitcnt vmcnt(9)
    v_mfma_f32_16x16x32_bf16 a[0:3], v[52:55], v[72:75], a[0:3]
    v_mfma_f32_16x16x32_bf16 a[4:7], v[56:59], v[72:75], a[4:7]
    v_mfma_f32_16x16x32_bf16 a[8:11], v[60:63], v[72:75], a[8:11]
    v_mfma_f32_16x16x32_bf16 a[12:15], v[64:67], v[72:75], a[12:15]
    v_mfma_f32_16x16x32_bf16 a[16:19], v[68:71], v[72:75], a[16:19]
    v_mfma_f32_16x16x32_bf16 a[20:23], v[52:55], v[76:79], a[20:23]
    v_mfma_f32_16x16x32_bf16 a[24:27], v[56:59], v[76:79], a[24:27]
    v_mfma_f32_16x16x32_bf16 a[28:31], v[60:63], v[76:79], a[28:31]
    v_mfma_f32_16x16x32_bf16 a[32:35], v[64:67], v[76:79], a[32:35]
    v_mfma_f32_16x16x32_bf16 a[36:39], v[68:71], v[76:79], a[36:39]
    v_mfma_f32_16x16x32_bf16 v[88:91], v[52:55], v[80:83], v[88:91]
    v_mfma_f32_16x16x32_bf16 v[92:95], v[56:59], v[80:83], v[92:95]
    v_mfma_f32_16x16x32_bf16 v[96:99], v[60:63], v[80:83], v[96:99]
    v_mfma_f32_16x16x32_bf16 v[100:103], v[64:67], v[80:83], v[100:103]
    v_mfma_f32_16x16x32_bf16 v[104:107], v[68:71], v[80:83], v[104:107]
    v_mfma_f32_16x16x32_bf16 v[108:111], v[52:55], v[84:87], v[108:111]
    v_mfma_f32_16x16x32_bf16 v[112:115], v[56:59], v[84:87], v[112:115]
    v_mfma_f32_16x16x32_bf16 v[116:119], v[60:63], v[84:87], v[116:119]
    v_mfma_f32_16x16x32_bf16 v[120:123], v[64:67], v[84:87], v[120:123]
    v_mfma_f32_16x16x32_bf16 v[124:127], v[68:71], v[84:87], v[124:127]
    buffer_load_dwordx4 v[52:55], v7, s[28:31], s40 offen
    buffer_load_dwordx4 v[56:59], v7, s[28:31], s41 offen
    buffer_load_dwordx4 v[60:63], v7, s[28:31], s42 offen
    buffer_load_dwordx4 v[64:67], v7, s[28:31], s43 offen
    buffer_load_dwordx4 v[68:71], v7, s[28:31], s44 offen
    buffer_load_dwordx4 v[72:75], v7, s[28:31], s45 offen
    buffer_load_dwordx4 v[76:79], v7, s[28:31], s46 offen
    buffer_load_dwordx4 v[80:83], v7, s[28:31], s47 offen
    buffer_load_dwordx4 v[84:87], v7, s[28:31], s48 offen
    v_add_u32 v7, 8192, v7
    s_waitcnt vmcnt(9)
    v_mfma_f32_16x16x32_bf16 a[0:3], v[16:19], v[36:39], a[0:3]
    v_mfma_f32_16x16x32_bf16 a[4:7], v[20:23], v[36:39], a[4:7]
    v_mfma_f32_16x16x32_bf16 a[8:11], v[24:27], v[36:39], a[8:11]
    v_mfma_f32_16x16x32_bf16 a[12:15], v[28:31], v[36:39], a[12:15]
    v_mfma_f32_16x16x32_bf16 a[16:19], v[32:35], v[36:39], a[16:19]
    v_mfma_f32_16x16x32_bf16 a[20:23], v[16:19], v[40:43], a[20:23]
    v_mfma_f32_16x16x32_bf16 a[24:27], v[20:23], v[40:43], a[24:27]
    v_mfma_f32_16x16x32_bf16 a[28:31], v[24:27], v[40:43], a[28:31]
    v_mfma_f32_16x16x32_bf16 a[32:35], v[28:31], v[40:43], a[32:35]
    v_mfma_f32_16x16x32_bf16 a[36:39], v[32:35], v[40:43], a[36:39]
    v_mfma_f32_16x16x32_bf16 v[88:91], v[16:19], v[44:47], v[88:91]
    v_mfma_f32_16x16x32_bf16 v[92:95], v[20:23], v[44:47], v[92:95]
    v_mfma_f32_16x16x32_bf16 v[96:99], v[24:27], v[44:47], v[96:99]
    v_mfma_f32_16x16x32_bf16 v[100:103], v[28:31], v[44:47], v[100:103]
    v_mfma_f32_16x16x32_bf16 v[104:107], v[32:35], v[44:47], v[104:107]
    v_mfma_f32_16x16x32_bf16 v[108:111], v[16:19], v[48:51], v[108:111]
    v_mfma_f32_16x16x32_bf16 v[112:115], v[20:23], v[48:51], v[112:115]
    v_mfma_f32_16x16x32_bf16 v[116:119], v[24:27], v[48:51], v[116:119]
    v_mfma_f32_16x16x32_bf16 v[120:123], v[28:31], v[48:51], v[120:123]
    v_mfma_f32_16x16x32_bf16 v[124:127], v[32:35], v[48:51], v[124:127]
    buffer_load_dwordx4 v[16:19], v7, s[28:31], s40 offen
    buffer_load_dwordx4 v[20:23], v7, s[28:31], s41 offen
    buffer_load_dwordx4 v[24:27], v7, s[28:31], s42 offen
    buffer_load_dwordx4 v[28:31], v7, s[28:31], s43 offen
    buffer_load_dwordx4 v[32:35], v7, s[28:31], s44 offen
    buffer_load_dwordx4 v[36:39], v7, s[28:31], s45 offen
    buffer_load_dwordx4 v[40:43], v7, s[28:31], s46 offen
    buffer_load_dwordx4 v[44:47], v7, s[28:31], s47 offen
    buffer_load_dwordx4 v[48:51], v7, s[28:31], s48 offen
    v_add_u32 v7, 8192, v7
    s_waitcnt vmcnt(9)
    v_mfma_f32_16x16x32_bf16 a[0:3], v[52:55], v[72:75], a[0:3]
    v_mfma_f32_16x16x32_bf16 a[4:7], v[56:59], v[72:75], a[4:7]
    v_mfma_f32_16x16x32_bf16 a[8:11], v[60:63], v[72:75], a[8:11]
    v_mfma_f32_16x16x32_bf16 a[12:15], v[64:67], v[72:75], a[12:15]
    v_mfma_f32_16x16x32_bf16 a[16:19], v[68:71], v[72:75], a[16:19]
    v_mfma_f32_16x16x32_bf16 a[20:23], v[52:55], v[76:79], a[20:23]
    v_mfma_f32_16x16x32_bf16 a[24:27], v[56:59], v[76:79], a[24:27]
    v_mfma_f32_16x16x32_bf16 a[28:31], v[60:63], v[76:79], a[28:31]
    v_mfma_f32_16x16x32_bf16 a[32:35], v[64:67], v[76:79], a[32:35]
    v_mfma_f32_16x16x32_bf16 a[36:39], v[68:71], v[76:79], a[36:39]
    v_mfma_f32_16x16x32_bf16 v[88:91], v[52:55], v[80:83], v[88:91]
    v_mfma_f32_16x16x32_bf16 v[92:95], v[56:59], v[80:83], v[92:95]
    v_mfma_f32_16x16x32_bf16 v[96:99], v[60:63], v[80:83], v[96:99]
    v_mfma_f32_16x16x32_bf16 v[100:103], v[64:67], v[80:83], v[100:103]
    v_mfma_f32_16x16x32_bf16 v[104:107], v[68:71], v[80:83], v[104:107]
    v_mfma_f32_16x16x32_bf16 v[108:111], v[52:55], v[84:87], v[108:111]
    v_mfma_f32_16x16x32_bf16 v[112:115], v[56:59], v[84:87], v[112:115]
    v_mfma_f32_16x16x32_bf16 v[116:119], v[60:63], v[84:87], v[116:119]
    v_mfma_f32_16x16x32_bf16 v[120:123], v[64:67], v[84:87], v[120:123]
    v_mfma_f32_16x16x32_bf16 v[124:127], v[68:71], v[84:87], v[124:127]
    buffer_load_dwordx4 v[52:55], v7, s[28:31], s40 offen
    buffer_load_dwordx4 v[56:59], v7, s[28:31], s41 offen
    buffer_load_dwordx4 v[60:63], v7, s[28:31], s42 offen
    buffer_load_dwordx4 v[64:67], v7, s[28:31], s43 offen
    buffer_load_dwordx4 v[68:71], v7, s[28:31], s44 offen
    buffer_load_dwordx4 v[72:75], v7, s[28:31], s45 offen
    buffer_load_dwordx4 v[76:79], v7, s[28:31], s46 offen
    buffer_load_dwordx4 v[80:83], v7, s[28:31], s47 offen
    buffer_load_dwordx4 v[84:87], v7, s[28:31], s48 offen
    v_add_u32 v7, 8192, v7
    s_waitcnt vmcnt(9)
    v_mfma_f32_16x16x32_bf16 a[0:3], v[16:19], v[36:39], a[0:3]
    v_mfma_f32_16x16x32_bf16 a[4:7], v[20:23], v[36:39], a[4:7]
    v_mfma_f32_16x16x32_bf16 a[8:11], v[24:27], v[36:39], a[8:11]
    v_mfma_f32_16x16x32_bf16 a[12:15], v[28:31], v[36:39], a[12:15]
    v_mfma_f32_16x16x32_bf16 a[16:19], v[32:35], v[36:39], a[16:19]
    v_mfma_f32_16x16x32_bf16 a[20:23], v[16:19], v[40:43], a[20:23]
    v_mfma_f32_16x16x32_bf16 a[24:27], v[20:23], v[40:43], a[24:27]
    v_mfma_f32_16x16x32_bf16 a[28:31], v[24:27], v[40:43], a[28:31]
    v_mfma_f32_16x16x32_bf16 a[32:35], v[28:31], v[40:43], a[32:35]
    v_mfma_f32_16x16x32_bf16 a[36:39], v[32:35], v[40:43], a[36:39]
    v_mfma_f32_16x16x32_bf16 v[88:91], v[16:19], v[44:47], v[88:91]
    v_mfma_f32_16x16x32_bf16 v[92:95], v[20:23], v[44:47], v[92:95]
    v_mfma_f32_16x16x32_bf16 v[96:99], v[24:27], v[44:47], v[96:99]
    v_mfma_f32_16x16x32_bf16 v[100:103], v[28:31], v[44:47], v[100:103]
    v_mfma_f32_16x16x32_bf16 v[104:107], v[32:35], v[44:47], v[104:107]
    v_mfma_f32_16x16x32_bf16 v[108:111], v[16:19], v[48:51], v[108:111]
    v_mfma_f32_16x16x32_bf16 v[112:115], v[20:23], v[48:51], v[112:115]
    v_mfma_f32_16x16x32_bf16 v[116:119], v[24:27], v[48:51], v[116:119]
    v_mfma_f32_16x16x32_bf16 v[120:123], v[28:31], v[48:51], v[120:123]
    v_mfma_f32_16x16x32_bf16 v[124:127], v[32:35], v[48:51], v[124:127]
    buffer_load_dwordx4 v[16:19], v7, s[28:31], s40 offen
    buffer_load_dwordx4 v[20:23], v7, s[28:31], s41 offen
    buffer_load_dwordx4 v[24:27], v7, s[28:31], s42 offen
    buffer_load_dwordx4 v[28:31], v7, s[28:31], s43 offen
    buffer_load_dwordx4 v[32:35], v7, s[28:31], s44 offen
    buffer_load_dwordx4 v[36:39], v7, s[28:31], s45 offen
    buffer_load_dwordx4 v[40:43], v7, s[28:31], s46 offen
    buffer_load_dwordx4 v[44:47], v7, s[28:31], s47 offen
    buffer_load_dwordx4 v[48:51], v7, s[28:31], s48 offen
    v_add_u32 v7, 8192, v7
    s_waitcnt vmcnt(9)
    v_mfma_f32_16x16x32_bf16 a[0:3], v[52:55], v[72:75], a[0:3]
    v_mfma_f32_16x16x32_bf16 a[4:7], v[56:59], v[72:75], a[4:7]
    v_mfma_f32_16x16x32_bf16 a[8:11], v[60:63], v[72:75], a[8:11]
    v_mfma_f32_16x16x32_bf16 a[12:15], v[64:67], v[72:75], a[12:15]
    v_mfma_f32_16x16x32_bf16 a[16:19], v[68:71], v[72:75], a[16:19]
    v_mfma_f32_16x16x32_bf16 a[20:23], v[52:55], v[76:79], a[20:23]
    v_mfma_f32_16x16x32_bf16 a[24:27], v[56:59], v[76:79], a[24:27]
    v_mfma_f32_16x16x32_bf16 a[28:31], v[60:63], v[76:79], a[28:31]
    v_mfma_f32_16x16x32_bf16 a[32:35], v[64:67], v[76:79], a[32:35]
    v_mfma_f32_16x16x32_bf16 a[36:39], v[68:71], v[76:79], a[36:39]
    v_mfma_f32_16x16x32_bf16 v[88:91], v[52:55], v[80:83], v[88:91]
    v_mfma_f32_16x16x32_bf16 v[92:95], v[56:59], v[80:83], v[92:95]
    v_mfma_f32_16x16x32_bf16 v[96:99], v[60:63], v[80:83], v[96:99]
    v_mfma_f32_16x16x32_bf16 v[100:103], v[64:67], v[80:83], v[100:103]
    v_mfma_f32_16x16x32_bf16 v[104:107], v[68:71], v[80:83], v[104:107]
    v_mfma_f32_16x16x32_bf16 v[108:111], v[52:55], v[84:87], v[108:111]
    v_mfma_f32_16x16x32_bf16 v[112:115], v[56:59], v[84:87], v[112:115]
    v_mfma_f32_16x16x32_bf16 v[116:119], v[60:63], v[84:87], v[116:119]
    v_mfma_f32_16x16x32_bf16 v[120:123], v[64:67], v[84:87], v[120:123]
    v_mfma_f32_16x16x32_bf16 v[124:127], v[68:71], v[84:87], v[124:127]
    buffer_load_dwordx4 v[52:55], v7, s[28:31], s40 offen
    buffer_load_dwordx4 v[56:59], v7, s[28:31], s41 offen
    buffer_load_dwordx4 v[60:63], v7, s[28:31], s42 offen
    buffer_load_dwordx4 v[64:67], v7, s[28:31], s43 offen
    buffer_load_dwordx4 v[68:71], v7, s[28:31], s44 offen
    buffer_load_dwordx4 v[72:75], v7, s[28:31], s45 offen
    buffer_load_dwordx4 v[76:79], v7, s[28:31], s46 offen
    buffer_load_dwordx4 v[80:83], v7, s[28:31], s47 offen
    buffer_load_dwordx4 v[84:87], v7, s[28:31], s48 offen
    v_add_u32 v7, 8192, v7
    s_waitcnt vmcnt(9)
    v_mfma_f32_16x16x32_bf16 a[0:3], v[16:19], v[36:39], a[0:3]
    v_mfma_f32_16x16x32_bf16 a[4:7], v[20:23], v[36:39], a[4:7]
    v_mfma_f32_16x16x32_bf16 a[8:11], v[24:27], v[36:39], a[8:11]
    v_mfma_f32_16x16x32_bf16 a[12:15], v[28:31], v[36:39], a[12:15]
    v_mfma_f32_16x16x32_bf16 a[16:19], v[32:35], v[36:39], a[16:19]
    v_mfma_f32_16x16x32_bf16 a[20:23], v[16:19], v[40:43], a[20:23]
    v_mfma_f32_16x16x32_bf16 a[24:27], v[20:23], v[40:43], a[24:27]
    v_mfma_f32_16x16x32_bf16 a[28:31], v[24:27], v[40:43], a[28:31]
    v_mfma_f32_16x16x32_bf16 a[32:35], v[28:31], v[40:43], a[32:35]
    v_mfma_f32_16x16x32_bf16 a[36:39], v[32:35], v[40:43], a[36:39]
    v_mfma_f32_16x16x32_bf16 v[88:91], v[16:19], v[44:47], v[88:91]
    v_mfma_f32_16x16x32_bf16 v[92:95], v[20:23], v[44:47], v[92:95]
    v_mfma_f32_16x16x32_bf16 v[96:99], v[24:27], v[44:47], v[96:99]
    v_mfma_f32_16x16x32_bf16 v[100:103], v[28:31], v[44:47], v[100:103]
    v_mfma_f32_16x16x32_bf16 v[104:107], v[32:35], v[44:47], v[104:107]
    v_mfma_f32_16x16x32_bf16 v[108:111], v[16:19], v[48:51], v[108:111]
    v_mfma_f32_16x16x32_bf16 v[112:115], v[20:23], v[48:51], v[112:115]
    v_mfma_f32_16x16x32_bf16 v[116:119], v[24:27], v[48:51], v[116:119]
    v_mfma_f32_16x16x32_bf16 v[120:123], v[28:31], v[48:51], v[120:123]
    v_mfma_f32_16x16x32_bf16 v[124:127], v[32:35], v[48:51], v[124:127]
    buffer_load_dwordx4 v[16:19], v7, s[28:31], s40 offen
    buffer_load_dwordx4 v[20:23], v7, s[28:31], s41 offen
    buffer_load_dwordx4 v[24:27], v7, s[28:31], s42 offen
    buffer_load_dwordx4 v[28:31], v7, s[28:31], s43 offen
    buffer_load_dwordx4 v[32:35], v7, s[28:31], s44 offen
    buffer_load_dwordx4 v[36:39], v7, s[28:31], s45 offen
    buffer_load_dwordx4 v[40:43], v7, s[28:31], s46 offen
    buffer_load_dwordx4 v[44:47], v7, s[28:31], s47 offen
    buffer_load_dwordx4 v[48:51], v7, s[28:31], s48 offen
    v_add_u32 v7, 8192, v7
    s_waitcnt vmcnt(9)
    v_mfma_f32_16x16x32_bf16 a[0:3], v[52:55], v[72:75], a[0:3]
    v_mfma_f32_16x16x32_bf16 a[4:7], v[56:59], v[72:75], a[4:7]
    v_mfma_f32_16x16x32_bf16 a[8:11], v[60:63], v[72:75], a[8:11]
    v_mfma_f32_16x16x32_bf16 a[12:15], v[64:67], v[72:75], a[12:15]
    v_mfma_f32_16x16x32_bf16 a[16:19], v[68:71], v[72:75], a[16:19]
    v_mfma_f32_16x16x32_bf16 a[20:23], v[52:55], v[76:79], a[20:23]
    v_mfma_f32_16x16x32_bf16 a[24:27], v[56:59], v[76:79], a[24:27]
    v_mfma_f32_16x16x32_bf16 a[28:31], v[60:63], v[76:79], a[28:31]
    v_mfma_f32_16x16x32_bf16 a[32:35], v[64:67], v[76:79], a[32:35]
    v_mfma_f32_16x16x32_bf16 a[36:39], v[68:71], v[76:79], a[36:39]
    v_mfma_f32_16x16x32_bf16 v[88:91], v[52:55], v[80:83], v[88:91]
    v_mfma_f32_16x16x32_bf16 v[92:95], v[56:59], v[80:83], v[92:95]
    v_mfma_f32_16x16x32_bf16 v[96:99], v[60:63], v[80:83], v[96:99]
    v_mfma_f32_16x16x32_bf16 v[100:103], v[64:67], v[80:83], v[100:103]
    v_mfma_f32_16x16x32_bf16 v[104:107], v[68:71], v[80:83], v[104:107]
    v_mfma_f32_16x16x32_bf16 v[108:111], v[52:55], v[84:87], v[108:111]
    v_mfma_f32_16x16x32_bf16 v[112:115], v[56:59], v[84:87], v[112:115]
    v_mfma_f32_16x16x32_bf16 v[116:119], v[60:63], v[84:87], v[116:119]
    v_mfma_f32_16x16x32_bf16 v[120:123], v[64:67], v[84:87], v[120:123]
    v_mfma_f32_16x16x32_bf16 v[124:127], v[68:71], v[84:87], v[124:127]
    buffer_load_dwordx4 v[52:55], v7, s[28:31], s40 offen
    buffer_load_dwordx4 v[56:59], v7, s[28:31], s41 offen
    buffer_load_dwordx4 v[60:63], v7, s[28:31], s42 offen
    buffer_load_dwordx4 v[64:67], v7, s[28:31], s43 offen
    buffer_load_dwordx4 v[68:71], v7, s[28:31], s44 offen
    buffer_load_dwordx4 v[72:75], v7, s[28:31], s45 offen
    buffer_load_dwordx4 v[76:79], v7, s[28:31], s46 offen
    buffer_load_dwordx4 v[80:83], v7, s[28:31], s47 offen
    buffer_load_dwordx4 v[84:87], v7, s[28:31], s48 offen
    v_add_u32 v7, 8192, v7
    s_waitcnt vmcnt(9)
    v_mfma_f32_16x16x32_bf16 a[0:3], v[16:19], v[36:39], a[0:3]
    v_mfma_f32_16x16x32_bf16 a[4:7], v[20:23], v[36:39], a[4:7]
    v_mfma_f32_16x16x32_bf16 a[8:11], v[24:27], v[36:39], a[8:11]
    v_mfma_f32_16x16x32_bf16 a[12:15], v[28:31], v[36:39], a[12:15]
    v_mfma_f32_16x16x32_bf16 a[16:19], v[32:35], v[36:39], a[16:19]
    v_mfma_f32_16x16x32_bf16 a[20:23], v[16:19], v[40:43], a[20:23]
    v_mfma_f32_16x16x32_bf16 a[24:27], v[20:23], v[40:43], a[24:27]
    v_mfma_f32_16x16x32_bf16 a[28:31], v[24:27], v[40:43], a[28:31]
    v_mfma_f32_16x16x32_bf16 a[32:35], v[28:31], v[40:43], a[32:35]
    v_mfma_f32_16x16x32_bf16 a[36:39], v[32:35], v[40:43], a[36:39]
    v_mfma_f32_16x16x32_bf16 v[88:91], v[16:19], v[44:47], v[88:91]
    v_mfma_f32_16x16x32_bf16 v[92:95], v[20:23], v[44:47], v[92:95]
    v_mfma_f32_16x16x32_bf16 v[96:99], v[24:27], v[44:47], v[96:99]
    v_mfma_f32_16x16x32_bf16 v[100:103], v[28:31], v[44:47], v[100:103]
    v_mfma_f32_16x16x32_bf16 v[104:107], v[32:35], v[44:47], v[104:107]
    v_mfma_f32_16x16x32_bf16 v[108:111], v[16:19], v[48:51], v[108:111]
    v_mfma_f32_16x16x32_bf16 v[112:115], v[20:23], v[48:51], v[112:115]
    v_mfma_f32_16x16x32_bf16 v[116:119], v[24:27], v[48:51], v[116:119]
    v_mfma_f32_16x16x32_bf16 v[120:123], v[28:31], v[48:51], v[120:123]
    v_mfma_f32_16x16x32_bf16 v[124:127], v[32:35], v[48:51], v[124:127]
    buffer_load_dwordx4 v[16:19], v7, s[28:31], s40 offen
    buffer_load_dwordx4 v[20:23], v7, s[28:31], s41 offen
    buffer_load_dwordx4 v[24:27], v7, s[28:31], s42 offen
    buffer_load_dwordx4 v[28:31], v7, s[28:31], s43 offen
    buffer_load_dwordx4 v[32:35], v7, s[28:31], s44 offen
    buffer_load_dwordx4 v[36:39], v7, s[28:31], s45 offen
    buffer_load_dwordx4 v[40:43], v7, s[28:31], s46 offen
    buffer_load_dwordx4 v[44:47], v7, s[28:31], s47 offen
    buffer_load_dwordx4 v[48:51], v7, s[28:31], s48 offen
    v_add_u32 v7, 8192, v7
    s_waitcnt vmcnt(9)
    v_mfma_f32_16x16x32_bf16 a[0:3], v[52:55], v[72:75], a[0:3]
    v_mfma_f32_16x16x32_bf16 a[4:7], v[56:59], v[72:75], a[4:7]
    v_mfma_f32_16x16x32_bf16 a[8:11], v[60:63], v[72:75], a[8:11]
    v_mfma_f32_16x16x32_bf16 a[12:15], v[64:67], v[72:75], a[12:15]
    v_mfma_f32_16x16x32_bf16 a[16:19], v[68:71], v[72:75], a[16:19]
    v_mfma_f32_16x16x32_bf16 a[20:23], v[52:55], v[76:79], a[20:23]
    v_mfma_f32_16x16x32_bf16 a[24:27], v[56:59], v[76:79], a[24:27]
    v_mfma_f32_16x16x32_bf16 a[28:31], v[60:63], v[76:79], a[28:31]
    v_mfma_f32_16x16x32_bf16 a[32:35], v[64:67], v[76:79], a[32:35]
    v_mfma_f32_16x16x32_bf16 a[36:39], v[68:71], v[76:79], a[36:39]
    v_mfma_f32_16x16x32_bf16 v[88:91], v[52:55], v[80:83], v[88:91]
    v_mfma_f32_16x16x32_bf16 v[92:95], v[56:59], v[80:83], v[92:95]
    v_mfma_f32_16x16x32_bf16 v[96:99], v[60:63], v[80:83], v[96:99]
    v_mfma_f32_16x16x32_bf16 v[100:103], v[64:67], v[80:83], v[100:103]
    v_mfma_f32_16x16x32_bf16 v[104:107], v[68:71], v[80:83], v[104:107]
    v_mfma_f32_16x16x32_bf16 v[108:111], v[52:55], v[84:87], v[108:111]
    v_mfma_f32_16x16x32_bf16 v[112:115], v[56:59], v[84:87], v[112:115]
    v_mfma_f32_16x16x32_bf16 v[116:119], v[60:63], v[84:87], v[116:119]
    v_mfma_f32_16x16x32_bf16 v[120:123], v[64:67], v[84:87], v[120:123]
    v_mfma_f32_16x16x32_bf16 v[124:127], v[68:71], v[84:87], v[124:127]
    buffer_load_dwordx4 v[52:55], v7, s[28:31], s40 offen
    buffer_load_dwordx4 v[56:59], v7, s[28:31], s41 offen
    buffer_load_dwordx4 v[60:63], v7, s[28:31], s42 offen
    buffer_load_dwordx4 v[64:67], v7, s[28:31], s43 offen
    buffer_load_dwordx4 v[68:71], v7, s[28:31], s44 offen
    buffer_load_dwordx4 v[72:75], v7, s[28:31], s45 offen
    buffer_load_dwordx4 v[76:79], v7, s[28:31], s46 offen
    buffer_load_dwordx4 v[80:83], v7, s[28:31], s47 offen
    buffer_load_dwordx4 v[84:87], v7, s[28:31], s48 offen
    v_add_u32 v7, 8192, v7
    s_waitcnt vmcnt(9)
    v_mfma_f32_16x16x32_bf16 a[0:3], v[16:19], v[36:39], a[0:3]
    v_mfma_f32_16x16x32_bf16 a[4:7], v[20:23], v[36:39], a[4:7]
    v_mfma_f32_16x16x32_bf16 a[8:11], v[24:27], v[36:39], a[8:11]
    v_mfma_f32_16x16x32_bf16 a[12:15], v[28:31], v[36:39], a[12:15]
    v_mfma_f32_16x16x32_bf16 a[16:19], v[32:35], v[36:39], a[16:19]
    v_mfma_f32_16x16x32_bf16 a[20:23], v[16:19], v[40:43], a[20:23]
    v_mfma_f32_16x16x32_bf16 a[24:27], v[20:23], v[40:43], a[24:27]
    v_mfma_f32_16x16x32_bf16 a[28:31], v[24:27], v[40:43], a[28:31]
    v_mfma_f32_16x16x32_bf16 a[32:35], v[28:31], v[40:43], a[32:35]
    v_mfma_f32_16x16x32_bf16 a[36:39], v[32:35], v[40:43], a[36:39]
    v_mfma_f32_16x16x32_bf16 v[88:91], v[16:19], v[44:47], v[88:91]
    v_mfma_f32_16x16x32_bf16 v[92:95], v[20:23], v[44:47], v[92:95]
    v_mfma_f32_16x16x32_bf16 v[96:99], v[24:27], v[44:47], v[96:99]
    v_mfma_f32_16x16x32_bf16 v[100:103], v[28:31], v[44:47], v[100:103]
    v_mfma_f32_16x16x32_bf16 v[104:107], v[32:35], v[44:47], v[104:107]
    v_mfma_f32_16x16x32_bf16 v[108:111], v[16:19], v[48:51], v[108:111]
    v_mfma_f32_16x16x32_bf16 v[112:115], v[20:23], v[48:51], v[112:115]
    v_mfma_f32_16x16x32_bf16 v[116:119], v[24:27], v[48:51], v[116:119]
    v_mfma_f32_16x16x32_bf16 v[120:123], v[28:31], v[48:51], v[120:123]
    v_mfma_f32_16x16x32_bf16 v[124:127], v[32:35], v[48:51], v[124:127]
    s_lshl_b32 s94, s5, 3
    s_add_u32 s94, s94, s4
    s_lshl_b32 s94, s94, 9
    s_add_u32 s94, s94, 24641536
    v_min_u32 v15, 39, v2
    v_lshlrev_b32 v15, 3, v15
    buffer_load_dwordx2 v[12:13], v15, s[28:31], s94 offen sc0 sc1
    buffer_load_dwordx4 v[16:19], v7, s[28:31], s40 offen
    buffer_load_dwordx4 v[20:23], v7, s[28:31], s41 offen
    buffer_load_dwordx4 v[24:27], v7, s[28:31], s42 offen
    buffer_load_dwordx4 v[28:31], v7, s[28:31], s43 offen
    buffer_load_dwordx4 v[32:35], v7, s[28:31], s44 offen
    buffer_load_dwordx4 v[36:39], v7, s[28:31], s45 offen
    buffer_load_dwordx4 v[40:43], v7, s[28:31], s46 offen
    buffer_load_dwordx4 v[44:47], v7, s[28:31], s47 offen
    buffer_load_dwordx4 v[48:51], v7, s[28:31], s48 offen
    v_add_u32 v7, 8192, v7
    s_waitcnt vmcnt(10)
    v_mfma_f32_16x16x32_bf16 a[0:3], v[52:55], v[72:75], a[0:3]
    v_mfma_f32_16x16x32_bf16 a[4:7], v[56:59], v[72:75], a[4:7]
    v_mfma_f32_16x16x32_bf16 a[8:11], v[60:63], v[72:75], a[8:11]
    v_mfma_f32_16x16x32_bf16 a[12:15], v[64:67], v[72:75], a[12:15]
    v_mfma_f32_16x16x32_bf16 a[16:19], v[68:71], v[72:75], a[16:19]
    v_mfma_f32_16x16x32_bf16 a[20:23], v[52:55], v[76:79], a[20:23]
    v_mfma_f32_16x16x32_bf16 a[24:27], v[56:59], v[76:79], a[24:27]
    v_mfma_f32_16x16x32_bf16 a[28:31], v[60:63], v[76:79], a[28:31]
    v_mfma_f32_16x16x32_bf16 a[32:35], v[64:67], v[76:79], a[32:35]
    v_mfma_f32_16x16x32_bf16 a[36:39], v[68:71], v[76:79], a[36:39]
    v_mfma_f32_16x16x32_bf16 v[88:91], v[52:55], v[80:83], v[88:91]
    v_mfma_f32_16x16x32_bf16 v[92:95], v[56:59], v[80:83], v[92:95]
    v_mfma_f32_16x16x32_bf16 v[96:99], v[60:63], v[80:83], v[96:99]
    v_mfma_f32_16x16x32_bf16 v[100:103], v[64:67], v[80:83], v[100:103]
    v_mfma_f32_16x16x32_bf16 v[104:107], v[68:71], v[80:83], v[104:107]
    v_mfma_f32_16x16x32_bf16 v[108:111], v[52:55], v[84:87], v[108:111]
    v_mfma_f32_16x16x32_bf16 v[112:115], v[56:59], v[84:87], v[112:115]
    v_mfma_f32_16x16x32_bf16 v[116:119], v[60:63], v[84:87], v[116:119]
    v_mfma_f32_16x16x32_bf16 v[120:123], v[64:67], v[84:87], v[120:123]
    v_mfma_f32_16x16x32_bf16 v[124:127], v[68:71], v[84:87], v[124:127]
    s_cmp_ge_u32 s3, 2
    s_cselect_b32 s6, 8192, 0
    v_subrev_u32 v7, s6, v7
    buffer_load_dwordx4 v[52:55], v7, s[28:31], s40 offen
    buffer_load_dwordx4 v[56:59], v7, s[28:31], s41 offen
    buffer_load_dwordx4 v[60:63], v7, s[28:31], s42 offen
    buffer_load_dwordx4 v[64:67], v7, s[28:31], s43 offen
    buffer_load_dwordx4 v[68:71], v7, s[28:31], s44 offen
    buffer_load_dwordx4 v[72:75], v7, s[28:31], s45 offen
    buffer_load_dwordx4 v[76:79], v7, s[28:31], s46 offen
    buffer_load_dwordx4 v[80:83], v7, s[28:31], s47 offen
    buffer_load_dwordx4 v[84:87], v7, s[28:31], s48 offen
    v_add_u32 v7, 8192, v7
    s_waitcnt vmcnt(9)
    v_mfma_f32_16x16x32_bf16 a[0:3], v[16:19], v[36:39], a[0:3]
    v_mfma_f32_16x16x32_bf16 a[4:7], v[20:23], v[36:39], a[4:7]
    v_mfma_f32_16x16x32_bf16 a[8:11], v[24:27], v[36:39], a[8:11]
    v_mfma_f32_16x16x32_bf16 a[12:15], v[28:31], v[36:39], a[12:15]
    v_mfma_f32_16x16x32_bf16 a[16:19], v[32:35], v[36:39], a[16:19]
    v_mfma_f32_16x16x32_bf16 a[20:23], v[16:19], v[40:43], a[20:23]
    v_mfma_f32_16x16x32_bf16 a[24:27], v[20:23], v[40:43], a[24:27]
    v_mfma_f32_16x16x32_bf16 a[28:31], v[24:27], v[40:43], a[28:31]
    v_mfma_f32_16x16x32_bf16 a[32:35], v[28:31], v[40:43], a[32:35]
    v_mfma_f32_16x16x32_bf16 a[36:39], v[32:35], v[40:43], a[36:39]
    v_mfma_f32_16x16x32_bf16 v[88:91], v[16:19], v[44:47], v[88:91]
    v_mfma_f32_16x16x32_bf16 v[92:95], v[20:23], v[44:47], v[92:95]
    v_mfma_f32_16x16x32_bf16 v[96:99], v[24:27], v[44:47], v[96:99]
    v_mfma_f32_16x16x32_bf16 v[100:103], v[28:31], v[44:47], v[100:103]
    v_mfma_f32_16x16x32_bf16 v[104:107], v[32:35], v[44:47], v[104:107]
    v_mfma_f32_16x16x32_bf16 v[108:111], v[16:19], v[48:51], v[108:111]
    v_mfma_f32_16x16x32_bf16 v[112:115], v[20:23], v[48:51], v[112:115]
    v_mfma_f32_16x16x32_bf16 v[116:119], v[24:27], v[48:51], v[116:119]
    v_mfma_f32_16x16x32_bf16 v[120:123], v[28:31], v[48:51], v[120:123]
    v_mfma_f32_16x16x32_bf16 v[124:127], v[32:35], v[48:51], v[124:127]
    s_mov_b32 s91, 0
    s_branch fp1_c
fp1_p:
    buffer_load_dwordx2 v[12:13], v15, s[28:31], s94 offen sc0 sc1
    s_waitcnt vmcnt(0)
fp1_c:
    v_and_b32 v12, v12, v13
    v_cmp_ne_u32 vcc, 1, v12
    s_cmp_eq_u64 vcc, 0
    s_cbranch_scc1 fp1_d
    s_add_u32 s91, s91, 1
    s_cmp_ge_u32 s91, 0x20000
    s_cbranch_scc1 fp1_d
    s_sleep 8
    s_branch fp1_p
fp1_d:
    buffer_load_dwordx2 v[16:17], v9, s[8:11], 0 offen offset:0
    buffer_load_dwordx2 v[18:19], v9, s[8:11], 0 offen offset:32
    buffer_load_dwordx2 v[20:21], v9, s[8:11], 0 offen offset:64
    buffer_load_dwordx2 v[22:23], v9, s[8:11], 0 offen offset:96
    buffer_load_dwordx2 v[24:25], v9, s[8:11], 0 offen offset:128
    v_lshlrev_b32 v10, 14, v4
    v_lshl_add_u32 v10, v8, 1, v10
    s_mul_i32 s6, s4, 327680
    s_add_u32 s6, s6, 20971520
    buffer_load_ushort v26, v10, s[28:31], s6 offen
    s_add_u32 s6, s6, 4096
    buffer_load_ushort v27, v10, s[28:31], s6 offen
    s_add_u32 s6, s6, 4096
    buffer_load_ushort v28, v10, s[28:31], s6 offen
    s_add_u32 s6, s6, 4096
    buffer_load_ushort v29, v10, s[28:31], s6 offen
    s_add_u32 s6, s6, 53248
    buffer_load_ushort v30, v10, s[28:31], s6 offen
    s_add_u32 s6, s6, 4096
    buffer_load_ushort v31, v10, s[28:31], s6 offen
    s_add_u32 s6, s6, 4096
    buffer_load_ushort v32, v10, s[28:31], s6 offen
    s_add_u32 s6, s6, 4096
    buffer_load_ushort v33, v10, s[28:31], s6 offen
    s_add_u32 s6, s6, 53248
    buffer_load_ushort v34, v10, s[28:31], s6 offen
    s_add_u32 s6, s6, 4096
    buffer_load_ushort v35, v10, s[28:31], s6 offen
    s_add_u32 s6, s6, 4096
    buffer_load_ushort v36, v10, s[28:31], s6 offen
    s_add_u32 s6, s6, 4096
    buffer_load_ushort v37, v10, s[28:31], s6 offen
    s_add_u32 s6, s6, 53248
    buffer_load_ushort v38, v10, s[28:31], s6 offen
    s_add_u32 s6, s6, 4096
    buffer_load_ushort v39, v10, s[28:31], s6 offen
    s_add_u32 s6, s6, 4096
    buffer_load_ushort v40, v10, s[28:31], s6 offen
    s_add_u32 s6, s6, 4096
    buffer_load_ushort v41, v10, s[28:31], s6 offen
    s_add_u32 s6, s6, 53248
    buffer_load_ushort v42, v10, s[28:31], s6 offen
    s_add_u32 s6, s6, 4096
    buffer_load_ushort v43, v10, s[28:31], s6 offen
    s_add_u32 s6, s6, 4096
    buffer_load_ushort v44, v10, s[28:31], s6 offen
    s_add_u32 s6, s6, 4096
    buffer_load_ushort v45, v10, s[28:31], s6 offen
    s_add_u32 s6, s6, 53248
    s_cmp_ge_u32 s3, 2
    s_cbranch_scc1 fin_red
    s_waitcnt vmcnt(25)
    v_mfma_f32_16x16x32_bf16 a[0:3], v[52:55], v[72:75], a[0:3]
    v_mfma_f32_16x16x32_bf16 a[4:7], v[56:59], v[72:75], a[4:7]
    v_mfma_f32_16x16x32_bf16 a[8:11], v[60:63], v[72:75], a[8:11]
    v_mfma_f32_16x16x32_bf16 a[12:15], v[64:67], v[72:75], a[12:15]
    v_mfma_f32_16x16x32_bf16 a[16:19], v[68:71], v[72:75], a[16:19]
    v_mfma_f32_16x16x32_bf16 a[20:23], v[52:55], v[76:79], a[20:23]
    v_mfma_f32_16x16x32_bf16 a[24:27], v[56:59], v[76:79], a[24:27]
    v_mfma_f32_16x16x32_bf16 a[28:31], v[60:63], v[76:79], a[28:31]
    v_mfma_f32_16x16x32_bf16 a[32:35], v[64:67], v[76:79], a[32:35]
    v_mfma_f32_16x16x32_bf16 a[36:39], v[68:71], v[76:79], a[36:39]
    v_mfma_f32_16x16x32_bf16 v[88:91], v[52:55], v[80:83], v[88:91]
    v_mfma_f32_16x16x32_bf16 v[92:95], v[56:59], v[80:83], v[92:95]
    v_mfma_f32_16x16x32_bf16 v[96:99], v[60:63], v[80:83], v[96:99]
    v_mfma_f32_16x16x32_bf16 v[100:103], v[64:67], v[80:83], v[100:103]
    v_mfma_f32_16x16x32_bf16 v[104:107], v[68:71], v[80:83], v[104:107]
    v_mfma_f32_16x16x32_bf16 v[108:111], v[52:55], v[84:87], v[108:111]
    v_mfma_f32_16x16x32_bf16 v[112:115], v[56:59], v[84:87], v[112:115]
    v_mfma_f32_16x16x32_bf16 v[116:119], v[60:63], v[84:87], v[116:119]
    v_mfma_f32_16x16x32_bf16 v[120:123], v[64:67], v[84:87], v[120:123]
    v_mfma_f32_16x16x32_bf16 v[124:127], v[68:71], v[84:87], v[124:127]
fin_red:
    s_nop 15
    s_waitcnt vmcnt(25)
    v_lshlrev_b32 v11, 4, v2
    s_xor_b32 s6, s3, 2
    s_mul_i32 s6, s6, 10240
    v_add_u32 v12, s6, v11
    s_mul_i32 s6, s3, 10240
    v_add_u32 v13, s6, v11
    s_xor_b32 s6, s3, 1
    s_mul_i32 s6, s6, 10240
    v_add_u32 v15, s6, v11
    s_cmp_ge_u32 s3, 2
    s_cbranch_scc1 fr_hi
    ds_write_b128 v12, v[88:91] offset:0
    ds_write_b128 v12, v[92:95] offset:1024
    ds_write_b128 v12, v[96:99] offset:2048
    ds_write_b128 v12, v[100:103] offset:3072
    ds_write_b128 v12, v[104:107] offset:4096
    ds_write_b128 v12, v[108:111] offset:5120
    ds_write_b128 v12, v[112:115] offset:6144
    ds_write_b128 v12, v[116:119] offset:7168
    ds_write_b128 v12, v[120:123] offset:8192
    ds_write_b128 v12, v[124:127] offset:9216
    s_waitcnt lgkmcnt(0)
    v_accvgpr_read_b32 v88, a0
    v_accvgpr_read_b32 v89, a1
    v_accvgpr_read_b32 v90, a2
    v_accvgpr_read_b32 v91, a3
    v_accvgpr_read_b32 v92, a4
    v_accvgpr_read_b32 v93, a5
    v_accvgpr_read_b32 v94, a6
    v_accvgpr_read_b32 v95, a7
    v_accvgpr_read_b32 v96, a8
    v_accvgpr_read_b32 v97, a9
    v_accvgpr_read_b32 v98, a10
    v_accvgpr_read_b32 v99, a11
    v_accvgpr_read_b32 v100, a12
    v_accvgpr_read_b32 v101, a13
    v_accvgpr_read_b32 v102, a14
    v_accvgpr_read_b32 v103, a15
    v_accvgpr_read_b32 v104, a16
    v_accvgpr_read_b32 v105, a17
    v_accvgpr_read_b32 v106, a18
    v_accvgpr_read_b32 v107, a19
    v_accvgpr_read_b32 v108, a20
    v_accvgpr_read_b32 v109, a21
    v_accvgpr_read_b32 v110, a22
    v_accvgpr_read_b32 v111, a23
    v_accvgpr_read_b32 v112, a24
    v_accvgpr_read_b32 v113, a25
    v_accvgpr_read_b32 v114, a26
    v_accvgpr_read_b32 v115, a27
    v_accvgpr_read_b32 v116, a28
    v_accvgpr_read_b32 v117, a29
    v_accvgpr_read_b32 v118, a30
    v_accvgpr_read_b32 v119, a31
    v_accvgpr_read_b32 v120, a32
    v_accvgpr_read_b32 v121, a33
    v_accvgpr_read_b32 v122, a34
    v_accvgpr_read_b32 v123, a35
    v_accvgpr_read_b32 v124, a36
    v_accvgpr_read_b32 v125, a37
    v_accvgpr_read_b32 v126, a38
    v_accvgpr_read_b32 v127, a39
    s_branch fr_j
fr_hi:
    ds_write_b128 v12, a[0:3] offset:0
    ds_write_b128 v12, a[4:7] offset:1024
    ds_write_b128 v12, a[8:11] offset:2048
    ds_write_b128 v12, a[12:15] offset:3072
    ds_write_b128 v12, a[16:19] offset:4096
    ds_write_b128 v12, a[20:23] offset:5120
    ds_write_b128 v12, a[24:27] offset:6144
    ds_write_b128 v12, a[28:31] offset:7168
    ds_write_b128 v12, a[32:35] offset:8192
    ds_write_b128 v12, a[36:39] offset:9216
    s_waitcnt lgkmcnt(0)
fr_j:
    s_barrier
    ds_read_b128 v[46:49], v13 offset:0
    ds_read_b128 v[50:53], v13 offset:1024
    ds_read_b128 v[54:57], v13 offset:2048
    ds_read_b128 v[58:61], v13 offset:3072
    ds_read_b128 v[62:65], v13 offset:4096
    ds_read_b128 v[66:69], v13 offset:5120
    ds_read_b128 v[70:73], v13 offset:6144
    ds_read_b128 v[74:77], v13 offset:7168
    ds_read_b128 v[78:81], v13 offset:8192
    ds_read_b128 v[82:85], v13 offset:9216
    s_waitcnt lgkmcnt(9)
    v_pk_add_f32 v[46:47], v[46:47], v[88:89]
    v_pk_add_f32 v[48:49], v[48:49], v[90:91]
    s_waitcnt lgkmcnt(8)
    v_pk_add_f32 v[50:51], v[50:51], v[92:93]
    v_pk_add_f32 v[52:53], v[52:53], v[94:95]
    s_waitcnt lgkmcnt(7)
    v_pk_add_f32 v[54:55], v[54:55], v[96:97]
    v_pk_add_f32 v[56:57], v[56:57], v[98:99]
    s_waitcnt lgkmcnt(6)
    v_pk_add_f32 v[58:59], v[58:59], v[100:101]
    v_pk_add_f32 v[60:61], v[60:61], v[102:103]
    s_waitcnt lgkmcnt(5)
    v_pk_add_f32 v[62:63], v[62:63], v[104:105]
    v_pk_add_f32 v[64:65], v[64:65], v[106:107]
    s_waitcnt lgkmcnt(4)
    v_pk_add_f32 v[66:67], v[66:67], v[108:109]
    v_pk_add_f32 v[68:69], v[68:69], v[110:111]
    s_waitcnt lgkmcnt(3)
    v_pk_add_f32 v[70:71], v[70:71], v[112:113]
    v_pk_add_f32 v[72:73], v[72:73], v[114:115]
    s_waitcnt lgkmcnt(2)
    v_pk_add_f32 v[74:75], v[74:75], v[116:117]
    v_pk_add_f32 v[76:77], v[76:77], v[118:119]
    s_waitcnt lgkmcnt(1)
    v_pk_add_f32 v[78:79], v[78:79], v[120:121]
    v_pk_add_f32 v[80:81], v[80:81], v[122:123]
    s_waitcnt lgkmcnt(0)
    v_pk_add_f32 v[82:83], v[82:83], v[124:125]
    v_pk_add_f32 v[84:85], v[84:85], v[126:127]
    s_bitcmp1_b32 s3, 0
    s_cbranch_scc1 fr_odd
    ds_write_b128 v13, v[66:69] offset:0
    ds_write_b128 v13, v[70:73] offset:1024
    ds_write_b128 v13, v[74:77] offset:2048
    ds_write_b128 v13, v[78:81] offset:3072
    ds_write_b128 v13, v[82:85] offset:4096
    s_branch fr_j2
fr_odd:
    ds_write_b128 v13, v[46:49] offset:0
    ds_write_b128 v13, v[50:53] offset:1024
    ds_write_b128 v13, v[54:57] offset:2048
    ds_write_b128 v13, v[58:61] offset:3072
    ds_write_b128 v13, v[62:65] offset:4096
    s_waitcnt lgkmcnt(0)
    v_mov_b32 v46, v66
    v_mov_b32 v47, v67
    v_mov_b32 v48, v68
    v_mov_b32 v49, v69
    v_mov_b32 v50, v70
    v_mov_b32 v51, v71
    v_mov_b32 v52, v72
    v_mov_b32 v53, v73
    v_mov_b32 v54, v74
    v_mov_b32 v55, v75
    v_mov_b32 v56, v76
    v_mov_b32 v57, v77
    v_mov_b32 v58, v78
    v_mov_b32 v59, v79
    v_mov_b32 v60, v80
    v_mov_b32 v61, v81
    v_mov_b32 v62, v82
    v_mov_b32 v63, v83
    v_mov_b32 v64, v84
    v_mov_b32 v65, v85
fr_j2:
    s_waitcnt lgkmcnt(0)
    s_barrier
    ds_read_b128 v[88:91], v15 offset:0
    ds_read_b128 v[92:95], v15 offset:1024
    ds_read_b128 v[96:99], v15 offset:2048
    ds_read_b128 v[100:103], v15 offset:3072
    ds_read_b128 v[104:107], v15 offset:4096
    s_waitcnt lgkmcnt(4)
    v_pk_add_f32 v[46:47], v[46:47], v[88:89]
    v_pk_add_f32 v[48:49], v[48:49], v[90:91]
    s_waitcnt lgkmcnt(3)
    v_pk_add_f32 v[50:51], v[50:51], v[92:93]
    v_pk_add_f32 v[52:53], v[52:53], v[94:95]
    s_waitcnt lgkmcnt(2)
    v_pk_add_f32 v[54:55], v[54:55], v[96:97]
    v_pk_add_f32 v[56:57], v[56:57], v[98:99]
    s_waitcnt lgkmcnt(1)
    v_pk_add_f32 v[58:59], v[58:59], v[100:101]
    v_pk_add_f32 v[60:61], v[60:61], v[102:103]
    s_waitcnt lgkmcnt(0)
    v_pk_add_f32 v[62:63], v[62:63], v[104:105]
    v_pk_add_f32 v[64:65], v[64:65], v[106:107]
fin_rd:
    s_waitcnt vmcnt(0)
    v_lshlrev_b32 v108, 16, v16
    v_and_b32 v109, 0xffff0000, v16
    v_lshlrev_b32 v110, 16, v26
    v_lshlrev_b32 v111, 16, v27
    v_add_f32 v108, v108, v110
    v_add_f32 v109, v109, v111
    v_cvt_pk_bf16_f32 v108, v108, v109
    v_cvt_pk_bf16_f32 v110, v46, v47
    v_lshlrev_b32 v112, 16, v108
    v_and_b32 v113, 0xffff0000, v108
    v_lshlrev_b32 v114, 16, v110
    v_and_b32 v115, 0xffff0000, v110
    v_add_f32 v112, v112, v114
    v_add_f32 v113, v113, v115
    v_cvt_pk_bf16_f32 v16, v112, v113
    v_lshlrev_b32 v108, 16, v17
    v_and_b32 v109, 0xffff0000, v17
    v_lshlrev_b32 v110, 16, v28
    v_lshlrev_b32 v111, 16, v29
    v_add_f32 v108, v108, v110
    v_add_f32 v109, v109, v111
    v_cvt_pk_bf16_f32 v108, v108, v109
    v_cvt_pk_bf16_f32 v110, v48, v49
    v_lshlrev_b32 v112, 16, v108
    v_and_b32 v113, 0xffff0000, v108
    v_lshlrev_b32 v114, 16, v110
    v_and_b32 v115, 0xffff0000, v110
    v_add_f32 v112, v112, v114
    v_add_f32 v113, v113, v115
    v_cvt_pk_bf16_f32 v17, v112, v113
    buffer_store_dwordx2 v[16:17], v9, s[12:15], 0 offen offset:0
    v_lshlrev_b32 v108, 16, v18
    v_and_b32 v109, 0xffff0000, v18
    v_lshlrev_b32 v110, 16, v30
    v_lshlrev_b32 v111, 16, v31
    v_add_f32 v108, v108, v110
    v_add_f32 v109, v109, v111
    v_cvt_pk_bf16_f32 v108, v108, v109
    v_cvt_pk_bf16_f32 v110, v50, v51
    v_lshlrev_b32 v112, 16, v108
    v_and_b32 v113, 0xffff0000, v108
    v_lshlrev_b32 v114, 16, v110
    v_and_b32 v115, 0xffff0000, v110
    v_add_f32 v112, v112, v114
    v_add_f32 v113, v113, v115
    v_cvt_pk_bf16_f32 v18, v112, v113
    v_lshlrev_b32 v108, 16, v19
    v_and_b32 v109, 0xffff0000, v19
    v_lshlrev_b32 v110, 16, v32
    v_lshlrev_b32 v111, 16, v33
    v_add_f32 v108, v108, v110
    v_add_f32 v109, v109, v111
    v_cvt_pk_bf16_f32 v108, v108, v109
    v_cvt_pk_bf16_f32 v110, v52, v53
    v_lshlrev_b32 v112, 16, v108
    v_and_b32 v113, 0xffff0000, v108
    v_lshlrev_b32 v114, 16, v110
    v_and_b32 v115, 0xffff0000, v110
    v_add_f32 v112, v112, v114
    v_add_f32 v113, v113, v115
    v_cvt_pk_bf16_f32 v19, v112, v113
    buffer_store_dwordx2 v[18:19], v9, s[12:15], 0 offen offset:32
    v_lshlrev_b32 v108, 16, v20
    v_and_b32 v109, 0xffff0000, v20
    v_lshlrev_b32 v110, 16, v34
    v_lshlrev_b32 v111, 16, v35
    v_add_f32 v108, v108, v110
    v_add_f32 v109, v109, v111
    v_cvt_pk_bf16_f32 v108, v108, v109
    v_cvt_pk_bf16_f32 v110, v54, v55
    v_lshlrev_b32 v112, 16, v108
    v_and_b32 v113, 0xffff0000, v108
    v_lshlrev_b32 v114, 16, v110
    v_and_b32 v115, 0xffff0000, v110
    v_add_f32 v112, v112, v114
    v_add_f32 v113, v113, v115
    v_cvt_pk_bf16_f32 v20, v112, v113
    v_lshlrev_b32 v108, 16, v21
    v_and_b32 v109, 0xffff0000, v21
    v_lshlrev_b32 v110, 16, v36
    v_lshlrev_b32 v111, 16, v37
    v_add_f32 v108, v108, v110
    v_add_f32 v109, v109, v111
    v_cvt_pk_bf16_f32 v108, v108, v109
    v_cvt_pk_bf16_f32 v110, v56, v57
    v_lshlrev_b32 v112, 16, v108
    v_and_b32 v113, 0xffff0000, v108
    v_lshlrev_b32 v114, 16, v110
    v_and_b32 v115, 0xffff0000, v110
    v_add_f32 v112, v112, v114
    v_add_f32 v113, v113, v115
    v_cvt_pk_bf16_f32 v21, v112, v113
    buffer_store_dwordx2 v[20:21], v9, s[12:15], 0 offen offset:64
    v_lshlrev_b32 v108, 16, v22
    v_and_b32 v109, 0xffff0000, v22
    v_lshlrev_b32 v110, 16, v38
    v_lshlrev_b32 v111, 16, v39
    v_add_f32 v108, v108, v110
    v_add_f32 v109, v109, v111
    v_cvt_pk_bf16_f32 v108, v108, v109
    v_cvt_pk_bf16_f32 v110, v58, v59
    v_lshlrev_b32 v112, 16, v108
    v_and_b32 v113, 0xffff0000, v108
    v_lshlrev_b32 v114, 16, v110
    v_and_b32 v115, 0xffff0000, v110
    v_add_f32 v112, v112, v114
    v_add_f32 v113, v113, v115
    v_cvt_pk_bf16_f32 v22, v112, v113
    v_lshlrev_b32 v108, 16, v23
    v_and_b32 v109, 0xffff0000, v23
    v_lshlrev_b32 v110, 16, v40
    v_lshlrev_b32 v111, 16, v41
    v_add_f32 v108, v108, v110
    v_add_f32 v109, v109, v111
    v_cvt_pk_bf16_f32 v108, v108, v109
    v_cvt_pk_bf16_f32 v110, v60, v61
    v_lshlrev_b32 v112, 16, v108
    v_and_b32 v113, 0xffff0000, v108
    v_lshlrev_b32 v114, 16, v110
    v_and_b32 v115, 0xffff0000, v110
    v_add_f32 v112, v112, v114
    v_add_f32 v113, v113, v115
    v_cvt_pk_bf16_f32 v23, v112, v113
    buffer_store_dwordx2 v[22:23], v9, s[12:15], 0 offen offset:96
    v_lshlrev_b32 v108, 16, v24
    v_and_b32 v109, 0xffff0000, v24
    v_lshlrev_b32 v110, 16, v42
    v_lshlrev_b32 v111, 16, v43
    v_add_f32 v108, v108, v110
    v_add_f32 v109, v109, v111
    v_cvt_pk_bf16_f32 v108, v108, v109
    v_cvt_pk_bf16_f32 v110, v62, v63
    v_lshlrev_b32 v112, 16, v108
    v_and_b32 v113, 0xffff0000, v108
    v_lshlrev_b32 v114, 16, v110
    v_and_b32 v115, 0xffff0000, v110
    v_add_f32 v112, v112, v114
    v_add_f32 v113, v113, v115
    v_cvt_pk_bf16_f32 v24, v112, v113
    v_lshlrev_b32 v108, 16, v25
    v_and_b32 v109, 0xffff0000, v25
    v_lshlrev_b32 v110, 16, v44
    v_lshlrev_b32 v111, 16, v45
    v_add_f32 v108, v108, v110
    v_add_f32 v109, v109, v111
    v_cvt_pk_bf16_f32 v108, v108, v109
    v_cvt_pk_bf16_f32 v110, v64, v65
    v_lshlrev_b32 v112, 16, v108
    v_and_b32 v113, 0xffff0000, v108
    v_lshlrev_b32 v114, 16, v110
    v_and_b32 v115, 0xffff0000, v110
    v_add_f32 v112, v112, v114
    v_add_f32 v113, v113, v115
    v_cvt_pk_bf16_f32 v25, v112, v113
    buffer_store_dwordx2 v[24:25], v9, s[12:15], 0 offen offset:128
fin_end:
    s_endpgm
```
